```python
import torch

def _softmax(x, axis=-1):
    return torch.softmax(x, dim=axis)
def _gelu(x):
    return torch.nn.functional.gelu(x, approximate="tanh")
def _silu(x):
    return torch.nn.functional.silu(x)
def _sigmoid(x):
    return torch.sigmoid(x)
def _layernorm(x, axis=-1, eps=1e-5):
    m = x.mean(dim=axis, keepdim=True)
    v = x.var(dim=axis, keepdim=True, unbiased=False)
    return (x - m) / torch.sqrt(v + eps)
def _scatter_add(tgt, idx, src, axis=0):
    return tgt.clone().index_add_(axis, idx, src)
def _segment_sum(src, seg, n):
    out = torch.zeros((n,) + src.shape[1:], dtype=src.dtype)
    return out.index_add_(0, seg, src)
def _pad(x, pw):
    flat = tuple(v for pair in reversed(pw) for v in pair)
    return torch.nn.functional.pad(x, flat)

kernel_name = 'parallel_sum__mha_block_cached__glu_gated_glu__decode'

def setup_inputs():

    _w = (lambda a: (lambda t: t.to(torch.bfloat16) if t.is_floating_point() else t)(torch.as_tensor(a)))
    def _A_setup():
        B, Sq, D = 1, 1, 512
        H, Sk, Dh = 32, 32768, 128
        return {
            "x": _w((lambda *s: torch.randn(*s, dtype=torch.bfloat16) * 0.05)(B, Sq, D)),
            "k_cache": _w((lambda *s: torch.randn(*s, dtype=torch.bfloat16) * 3.2)(B, H, Sk, Dh)),
            "v_cache": _w((lambda *s: torch.randn(*s, dtype=torch.bfloat16) * 1.6)(B, H, Sk, Dh)),
            "wq": _w((lambda *s: torch.randn(*s, dtype=torch.bfloat16) * 3.2)(D, H * Dh) * (D ** -0.5)),
            "wo": _w((lambda *s: torch.randn(*s, dtype=torch.bfloat16) * 1.6)(H * Dh, D) * ((H * Dh) ** -0.5)),
        }
    _A_in = _A_setup()

    def _B_setup():
        B, S, D, F = 1, 1, 512, 1792
        return {
            "x": _w((lambda *s: torch.randn(*s, dtype=torch.bfloat16) * 0.05)(B, S, D)),
            "w_gate": _w((lambda *s: torch.randn(*s, dtype=torch.bfloat16) * 0.8)(D, F)),
            "w_up": _w((lambda *s: torch.randn(*s, dtype=torch.bfloat16) * 0.05)(D, F)),
            "w_down": _w((lambda *s: torch.randn(*s, dtype=torch.bfloat16) * 0.05)(F, D)),
        }
    _B_in = _B_setup()

    return {
        "A_x": _A_in["x"],
        "A_k_cache": _A_in["k_cache"],
        "A_v_cache": _A_in["v_cache"],
        "A_wq": _A_in["wq"],
        "A_wo": _A_in["wo"],
        "B_x": _B_in["x"],
        "B_w_gate": _B_in["w_gate"],
        "B_w_up": _B_in["w_up"],
        "B_w_down": _B_in["w_down"],
    }

def reference(A_x, A_k_cache, A_v_cache, A_wq, A_wo, B_x, B_w_gate, B_w_up, B_w_down):
    def _A_ref(x, k_cache, v_cache, wq, wo):
        B, Sq, D = x.shape
        H, Dh = 32, 128
        q = (lambda x, *d: x.permute(*d))((x @ wq).reshape(B, Sq, H, Dh), 0, 2, 1, 3)
        scores = torch.einsum("bhqd,bhkd->bhqk", q, k_cache) * (Dh ** -0.5)
        p = _softmax(scores, axis=-1)
        o = torch.einsum("bhqk,bhkd->bhqd", p, v_cache)
        return (lambda x, *d: x.permute(*d))(o, 0, 2, 1, 3).reshape(B, Sq, H * Dh) @ wo

    def _B_ref(x, w_gate, w_up, w_down):
        g = torch.einsum("bsd,df->bsf", x, w_gate)
        u = torch.einsum("bsd,df->bsf", x, w_up)
        h = _sigmoid(g) * u
        return torch.einsum("bsf,fd->bsd", h, w_down)

    x = A_x
    xn = _layernorm(x, axis=-1)
    return x + _A_ref(xn, A_k_cache, A_v_cache, A_wq, A_wo) + _B_ref(xn, B_w_gate, B_w_up, B_w_down)
```

```asm
; @launch grid=(256,1,1) block=(512,1,1) lds=27648
.amdgcn_target "amdgcn-amd-amdhsa--gfx950"
.text
.globl parallel_sum__mha_block_cached__glu_gated_glu__decode_kernel
.p2align 8
.type parallel_sum__mha_block_cached__glu_gated_glu__decode_kernel,@function
parallel_sum__mha_block_cached__glu_gated_glu__decode_kernel:
  s_cmp_ge_u32 s2, 256
  s_cbranch_scc1 L_end
  s_load_dwordx16 s[4:19], s[0:1], 0
  s_load_dwordx8 s[20:27], s[0:1], 64
  v_and_b32 v1, 63, v0
  v_lshrrev_b32 v40, 6, v0
  v_lshrrev_b32 v3, 4, v1
  v_readfirstlane_b32 s74, v40
  v_and_b32 v4, 15, v1
  s_mov_b32 s78, 0x3db504f3
  s_mov_b32 s79, 0x3fb8aa3b
  s_mov_b32 s80, 0xffff0000
  s_mov_b32 s87, 0x05040100
  s_mov_b32 s88, 0x07060302
  s_and_b32 s83, s2, 7
  s_lshr_b32 s84, s2, 3
  s_and_b32 s85, s84, 3
  s_lshl_b32 s72, s85, 1
  s_add_u32 s72, s72, s83
  s_and_b32 s72, s72, 7
  s_lshl_b32 s85, s85, 3
  s_add_u32 s72, s72, s85
  s_lshr_b32 s73, s84, 2
  s_lshl_b32 s81, s72, 3
  s_add_u32 s81, s81, s73
  s_lshl_b32 s90, s72, 2
  s_mul_i32 s82, s83, 28
  s_add_u32 s82, s82, s84
  s_cmp_lt_u32 s84, 28
  s_cselect_b32 s86, 1, 0
  s_cselect_b32 s82, s82, 0
  v_lshlrev_b32 v7, 4, v1
  v_lshlrev_b32 v57, 14, v3
  v_lshl_add_u32 v57, v4, 4, v57
  s_lshl_b32 s83, s74, 16
  s_lshl_b32 s84, s72, 8
  s_add_u32 s91, s83, s84
  s_lshl_b32 s84, s74, 12
  v_add_u32 v2, s84, v7
  s_lshl_b32 s85, s81, 20
  s_waitcnt lgkmcnt(0)
  s_mov_b32 s36, s10
  s_and_b32 s37, s11, 0xffff
  s_mov_b32 s38, 0x400000
  s_mov_b32 s39, 0x00020000
  s_mov_b32 s56, s4
  s_and_b32 s57, s5, 0xffff
  s_mov_b32 s58, 0x400
  s_mov_b32 s59, 0x00020000
  s_add_u32 s28, s6, s85
  s_addc_u32 s29, s7, 0
  s_and_b32 s29, s29, 0xffff
  s_mov_b32 s30, 0x100000
  s_mov_b32 s31, 0x00020000
  s_add_u32 s32, s8, s85
  s_addc_u32 s33, s9, 0
  s_and_b32 s33, s33, 0xffff
  s_mov_b32 s34, 0x100000
  s_mov_b32 s35, 0x00020000
  s_cmp_lg_u32 s74, 0
  s_cbranch_scc1 L_loads
  buffer_load_dwordx4 v[40:43], v7, s[56:59], 0 offen
  s_waitcnt vmcnt(0)
  v_lshlrev_b32 v32, 16, v40
  v_and_b32 v33, s80, v40
  v_lshlrev_b32 v34, 16, v41
  v_and_b32 v35, s80, v41
  v_lshlrev_b32 v36, 16, v42
  v_and_b32 v37, s80, v42
  v_lshlrev_b32 v38, 16, v43
  v_and_b32 v39, s80, v43
  v_add_f32 v22, v32, v33
  v_add_f32 v23, v34, v35
  v_add_f32 v24, v36, v37
  v_add_f32 v25, v38, v39
  v_add_f32 v22, v22, v23
  v_add_f32 v24, v24, v25
  v_add_f32 v22, v22, v24
  s_nop 1
  v_add_f32_dpp v22, v22, v22 row_ror:8 row_mask:0xf bank_mask:0xf
  s_nop 1
  v_add_f32_dpp v22, v22, v22 row_ror:4 row_mask:0xf bank_mask:0xf
  s_nop 1
  v_add_f32_dpp v22, v22, v22 row_ror:2 row_mask:0xf bank_mask:0xf
  s_nop 1
  v_add_f32_dpp v22, v22, v22 row_ror:1 row_mask:0xf bank_mask:0xf
  s_nop 1
  v_mov_b32 v23, v22
  s_nop 1
  v_permlane16_swap_b32 v22, v23
  s_nop 0
  v_add_f32 v22, v22, v23
  v_mov_b32 v23, v22
  s_nop 1
  v_permlane32_swap_b32 v22, v23
  s_nop 0
  v_add_f32 v22, v22, v23
  v_mul_f32 v22, 0x3b000000, v22
  v_sub_f32 v12, v32, v22
  v_sub_f32 v13, v33, v22
  v_sub_f32 v14, v34, v22
  v_sub_f32 v15, v35, v22
  v_sub_f32 v16, v36, v22
  v_sub_f32 v17, v37, v22
  v_sub_f32 v18, v38, v22
  v_sub_f32 v19, v39, v22
  v_mul_f32 v23, v12, v12
  v_mul_f32 v24, v13, v13
  v_fmac_f32 v23, v14, v14
  v_fmac_f32 v24, v15, v15
  v_fmac_f32 v23, v16, v16
  v_fmac_f32 v24, v17, v17
  v_fmac_f32 v23, v18, v18
  v_fmac_f32 v24, v19, v19
  v_add_f32 v23, v23, v24
  s_nop 1
  v_add_f32_dpp v23, v23, v23 row_ror:8 row_mask:0xf bank_mask:0xf
  s_nop 1
  v_add_f32_dpp v23, v23, v23 row_ror:4 row_mask:0xf bank_mask:0xf
  s_nop 1
  v_add_f32_dpp v23, v23, v23 row_ror:2 row_mask:0xf bank_mask:0xf
  s_nop 1
  v_add_f32_dpp v23, v23, v23 row_ror:1 row_mask:0xf bank_mask:0xf
  s_nop 1
  v_mov_b32 v24, v23
  s_nop 1
  v_permlane16_swap_b32 v23, v24
  s_nop 0
  v_add_f32 v23, v23, v24
  v_mov_b32 v24, v23
  s_nop 1
  v_permlane32_swap_b32 v23, v24
  s_nop 0
  v_add_f32 v23, v23, v24
  v_mul_f32 v23, 0x3b000000, v23
  v_cvt_pk_bf16_f32 v24, v22, v23
  v_lshlrev_b32 v22, 16, v24
  v_and_b32 v23, s80, v24
  v_add_f32 v23, 0x3727c5ac, v23
  v_sub_f32 v32, v32, v22
  v_sub_f32 v33, v33, v22
  v_sub_f32 v34, v34, v22
  v_sub_f32 v35, v35, v22
  v_sub_f32 v36, v36, v22
  v_sub_f32 v37, v37, v22
  v_sub_f32 v38, v38, v22
  v_sub_f32 v39, v39, v22
  v_cvt_pk_bf16_f32 v24, v23, v23
  v_lshlrev_b32 v23, 16, v24
  v_sqrt_f32 v23, v23
  v_cvt_pk_bf16_f32 v24, v32, v33
  v_lshlrev_b32 v32, 16, v24
  v_and_b32 v33, s80, v24
  v_cvt_pk_bf16_f32 v24, v34, v35
  v_lshlrev_b32 v34, 16, v24
  v_and_b32 v35, s80, v24
  v_cvt_pk_bf16_f32 v24, v36, v37
  v_lshlrev_b32 v36, 16, v24
  v_and_b32 v37, s80, v24
  v_cvt_pk_bf16_f32 v24, v38, v39
  v_lshlrev_b32 v38, 16, v24
  v_and_b32 v39, s80, v24
  v_cvt_pk_bf16_f32 v24, v23, v23
  v_lshlrev_b32 v23, 16, v24
  v_rcp_f32 v25, v23
  s_nop 0
  v_mul_f32 v12, v32, v25
  v_mul_f32 v13, v33, v25
  v_mul_f32 v14, v34, v25
  v_mul_f32 v15, v35, v25
  v_mul_f32 v16, v36, v25
  v_mul_f32 v17, v37, v25
  v_mul_f32 v18, v38, v25
  v_mul_f32 v19, v39, v25
  v_fma_f32 v26, -v12, v23, v32
  v_fma_f32 v32, v26, v25, v12
  v_fma_f32 v27, -v13, v23, v33
  v_fma_f32 v33, v27, v25, v13
  v_fma_f32 v28, -v14, v23, v34
  v_fma_f32 v34, v28, v25, v14
  v_fma_f32 v29, -v15, v23, v35
  v_fma_f32 v35, v29, v25, v15
  v_fma_f32 v26, -v16, v23, v36
  v_fma_f32 v36, v26, v25, v16
  v_fma_f32 v27, -v17, v23, v37
  v_fma_f32 v37, v27, v25, v17
  v_fma_f32 v28, -v18, v23, v38
  v_fma_f32 v38, v28, v25, v18
  v_fma_f32 v29, -v19, v23, v39
  v_fma_f32 v39, v29, v25, v19
  v_cvt_pk_bf16_f32 v8, v32, v33
  v_cvt_pk_bf16_f32 v9, v34, v35
  v_cvt_pk_bf16_f32 v10, v36, v37
  v_cvt_pk_bf16_f32 v11, v38, v39
  ds_write_b128 v7, v[8:11] offset:0
L_loads:
  s_mov_b32 s75, 0
  s_add_u32 s83, s73, 0
  s_and_b32 s83, s83, 7
  s_lshl_b32 s83, s83, 19
  s_add_u32 s83, s83, s91
  s_add_u32 s84, s83, 8192
  buffer_load_dwordx4 v[64:67], v57, s[36:39], s83 offen nt
  buffer_load_dwordx4 v[68:71], v57, s[36:39], s84 offen nt
  buffer_load_dwordx4 v[128:131], v2, s[28:31], s75 offen offset:0 nt
  buffer_load_dwordx4 v[132:135], v2, s[28:31], s75 offen offset:1024 nt
  buffer_load_dwordx4 v[136:139], v2, s[28:31], s75 offen offset:2048 nt
  buffer_load_dwordx4 v[140:143], v2, s[28:31], s75 offen offset:3072 nt
  buffer_load_dwordx4 v[144:147], v2, s[32:35], s75 offen offset:0 nt
  buffer_load_dwordx4 v[148:151], v2, s[32:35], s75 offen offset:1024 nt
  buffer_load_dwordx4 v[152:155], v2, s[32:35], s75 offen offset:2048 nt
  buffer_load_dwordx4 v[156:159], v2, s[32:35], s75 offen offset:3072 nt
  s_add_u32 s75, s75, 32768
  s_add_u32 s83, s73, 1
  s_and_b32 s83, s83, 7
  s_lshl_b32 s83, s83, 19
  s_add_u32 s83, s83, s91
  s_add_u32 s84, s83, 8192
  buffer_load_dwordx4 v[72:75], v57, s[36:39], s83 offen nt
  buffer_load_dwordx4 v[76:79], v57, s[36:39], s84 offen nt
  s_add_u32 s83, s73, 2
  s_and_b32 s83, s83, 7
  s_lshl_b32 s83, s83, 19
  s_add_u32 s83, s83, s91
  s_add_u32 s84, s83, 8192
  buffer_load_dwordx4 v[80:83], v57, s[36:39], s83 offen nt
  buffer_load_dwordx4 v[84:87], v57, s[36:39], s84 offen nt
  s_add_u32 s83, s73, 3
  s_and_b32 s83, s83, 7
  s_lshl_b32 s83, s83, 19
  s_add_u32 s83, s83, s91
  s_add_u32 s84, s83, 8192
  buffer_load_dwordx4 v[88:91], v57, s[36:39], s83 offen nt
  buffer_load_dwordx4 v[92:95], v57, s[36:39], s84 offen nt
  s_add_u32 s83, s73, 4
  s_and_b32 s83, s83, 7
  s_lshl_b32 s83, s83, 19
  s_add_u32 s83, s83, s91
  s_add_u32 s84, s83, 8192
  buffer_load_dwordx4 v[96:99], v57, s[36:39], s83 offen nt
  buffer_load_dwordx4 v[100:103], v57, s[36:39], s84 offen nt
  s_add_u32 s83, s73, 5
  s_and_b32 s83, s83, 7
  s_lshl_b32 s83, s83, 19
  s_add_u32 s83, s83, s91
  s_add_u32 s84, s83, 8192
  buffer_load_dwordx4 v[104:107], v57, s[36:39], s83 offen nt
  buffer_load_dwordx4 v[108:111], v57, s[36:39], s84 offen nt
  s_add_u32 s83, s73, 6
  s_and_b32 s83, s83, 7
  s_lshl_b32 s83, s83, 19
  s_add_u32 s83, s83, s91
  s_add_u32 s84, s83, 8192
  buffer_load_dwordx4 v[112:115], v57, s[36:39], s83 offen nt
  buffer_load_dwordx4 v[116:119], v57, s[36:39], s84 offen nt
  s_add_u32 s83, s73, 7
  s_and_b32 s83, s83, 7
  s_lshl_b32 s83, s83, 19
  s_add_u32 s83, s83, s91
  s_add_u32 s84, s83, 8192
  buffer_load_dwordx4 v[120:123], v57, s[36:39], s83 offen nt
  buffer_load_dwordx4 v[124:127], v57, s[36:39], s84 offen nt
  buffer_load_dwordx4 v[160:163], v2, s[28:31], s75 offen offset:0 nt
  buffer_load_dwordx4 v[164:167], v2, s[28:31], s75 offen offset:1024 nt
  buffer_load_dwordx4 v[168:171], v2, s[28:31], s75 offen offset:2048 nt
  buffer_load_dwordx4 v[172:175], v2, s[28:31], s75 offen offset:3072 nt
  buffer_load_dwordx4 v[176:179], v2, s[32:35], s75 offen offset:0 nt
  buffer_load_dwordx4 v[180:183], v2, s[32:35], s75 offen offset:1024 nt
  buffer_load_dwordx4 v[184:187], v2, s[32:35], s75 offen offset:2048 nt
  buffer_load_dwordx4 v[188:191], v2, s[32:35], s75 offen offset:3072 nt
  s_add_u32 s75, s75, 32768
  s_mov_b32 s44, s16
  s_and_b32 s45, s17, 0xffff
  s_mov_b32 s46, 0x1c0000
  s_mov_b32 s47, 0x00020000
  s_mov_b32 s48, s18
  s_and_b32 s49, s19, 0xffff
  s_mov_b32 s50, 0x1c0000
  s_mov_b32 s51, 0x00020000
  s_mov_b32 s52, s20
  s_and_b32 s53, s21, 0xffff
  s_mov_b32 s54, 0x1c0000
  s_mov_b32 s55, 0x00020000
  s_mov_b32 s60, s26
  s_and_b32 s61, s27, 0xffff
  s_mov_b32 s62, 0x101800
  s_mov_b32 s63, 0x00020000
  s_mov_b32 s64, s22
  s_and_b32 s65, s23, 0xffff
  s_mov_b32 s66, 0x400
  s_mov_b32 s67, 0x00020000
  s_mov_b32 s68, s24
  s_and_b32 s69, s25, 0xffff
  s_mov_b32 s70, 0x100
  s_mov_b32 s71, 0x00020000
  s_lshl_b32 s83, s72, 17
  s_add_u32 s40, s12, s83
  s_addc_u32 s41, s13, 0
  s_and_b32 s41, s41, 0xffff
  s_mov_b32 s42, 0x20000
  s_mov_b32 s43, 0x00020000
  s_lshl_b32 s83, s74, 4
  v_lshlrev_b32 v56, 2, v3
  v_add_u32 v56, s83, v56
  s_add_u32 s83, s73, 0
  s_and_b32 s83, s83, 7
  s_lshl_b32 s83, s83, 7
  v_add_u32 v12, s83, v56
  s_add_u32 s83, s73, 1
  s_and_b32 s83, s83, 7
  s_lshl_b32 s83, s83, 7
  v_add_u32 v13, s83, v56
  s_add_u32 s83, s73, 2
  s_and_b32 s83, s83, 7
  s_lshl_b32 s83, s83, 7
  v_add_u32 v14, s83, v56
  s_add_u32 s83, s73, 3
  s_and_b32 s83, s83, 7
  s_lshl_b32 s83, s83, 7
  v_add_u32 v15, s83, v56
  s_add_u32 s83, s73, 4
  s_and_b32 s83, s83, 7
  s_lshl_b32 s83, s83, 7
  v_add_u32 v16, s83, v56
  s_add_u32 s83, s73, 5
  s_and_b32 s83, s83, 7
  s_lshl_b32 s83, s83, 7
  v_add_u32 v17, s83, v56
  s_add_u32 s83, s73, 6
  s_and_b32 s83, s83, 7
  s_lshl_b32 s83, s83, 7
  v_add_u32 v18, s83, v56
  s_add_u32 s83, s73, 7
  s_and_b32 s83, s83, 7
  s_lshl_b32 s83, s83, 7
  v_add_u32 v19, s83, v56
  v_lshlrev_b32 v58, 1, v0
  s_waitcnt lgkmcnt(0)
  s_barrier
  ds_read_b32 v12, v12 offset:0
  ds_read_b32 v13, v13 offset:0
  ds_read_b32 v14, v14 offset:0
  ds_read_b32 v15, v15 offset:0
  ds_read_b32 v16, v16 offset:0
  ds_read_b32 v17, v17 offset:0
  ds_read_b32 v18, v18 offset:0
  ds_read_b32 v19, v19 offset:0
  ds_read_u16 v60, v58 offset:0
  buffer_load_dwordx4 v[192:195], v2, s[28:31], s75 offen offset:0 nt
  buffer_load_dwordx4 v[196:199], v2, s[28:31], s75 offen offset:1024 nt
  buffer_load_dwordx4 v[200:203], v2, s[28:31], s75 offen offset:2048 nt
  buffer_load_dwordx4 v[204:207], v2, s[28:31], s75 offen offset:3072 nt
  buffer_load_dwordx4 v[208:211], v2, s[32:35], s75 offen offset:0 nt
  buffer_load_dwordx4 v[212:215], v2, s[32:35], s75 offen offset:1024 nt
  buffer_load_dwordx4 v[216:219], v2, s[32:35], s75 offen offset:2048 nt
  buffer_load_dwordx4 v[220:223], v2, s[32:35], s75 offen offset:3072 nt
  s_add_u32 s75, s75, 32768
  v_and_b32 v26, 1, v3
  v_lshlrev_b32 v26, 3, v26
  v_lshrrev_b32 v27, 1, v3
  v_lshl_add_u32 v26, v27, 4, v26
  v_lshl_add_u32 v61, v4, 5, v26
  s_waitcnt lgkmcnt(0)
  v_lshlrev_b32 v60, 16, v60
  s_waitcnt vmcnt(28)
  v_perm_b32 v26, v68, v64, s87
  v_perm_b32 v27, v68, v64, s88
  v_dot2_f32_bf16 v32, v26, v12, 0
  v_dot2_f32_bf16 v33, v27, v12, 0
  v_perm_b32 v28, v69, v65, s87
  v_perm_b32 v29, v69, v65, s88
  v_dot2_f32_bf16 v34, v28, v12, 0
  v_dot2_f32_bf16 v35, v29, v12, 0
  v_perm_b32 v26, v70, v66, s87
  v_perm_b32 v27, v70, v66, s88
  v_dot2_f32_bf16 v36, v26, v12, 0
  v_dot2_f32_bf16 v37, v27, v12, 0
  v_perm_b32 v28, v71, v67, s87
  v_perm_b32 v29, v71, v67, s88
  v_dot2_f32_bf16 v38, v28, v12, 0
  v_dot2_f32_bf16 v39, v29, v12, 0
  v_perm_b32 v26, v76, v72, s87
  v_perm_b32 v27, v76, v72, s88
  v_dot2_f32_bf16 v32, v26, v13, v32
  v_dot2_f32_bf16 v33, v27, v13, v33
  v_perm_b32 v28, v77, v73, s87
  v_perm_b32 v29, v77, v73, s88
  v_dot2_f32_bf16 v34, v28, v13, v34
  v_dot2_f32_bf16 v35, v29, v13, v35
  v_perm_b32 v26, v78, v74, s87
  v_perm_b32 v27, v78, v74, s88
  v_dot2_f32_bf16 v36, v26, v13, v36
  v_dot2_f32_bf16 v37, v27, v13, v37
  v_perm_b32 v28, v79, v75, s87
  v_perm_b32 v29, v79, v75, s88
  v_dot2_f32_bf16 v38, v28, v13, v38
  v_dot2_f32_bf16 v39, v29, v13, v39
  s_waitcnt vmcnt(24)
  v_perm_b32 v26, v84, v80, s87
  v_perm_b32 v27, v84, v80, s88
  v_dot2_f32_bf16 v32, v26, v14, v32
  v_dot2_f32_bf16 v33, v27, v14, v33
  v_perm_b32 v28, v85, v81, s87
  v_perm_b32 v29, v85, v81, s88
  v_dot2_f32_bf16 v34, v28, v14, v34
  v_dot2_f32_bf16 v35, v29, v14, v35
  v_perm_b32 v26, v86, v82, s87
  v_perm_b32 v27, v86, v82, s88
  v_dot2_f32_bf16 v36, v26, v14, v36
  v_dot2_f32_bf16 v37, v27, v14, v37
  v_perm_b32 v28, v87, v83, s87
  v_perm_b32 v29, v87, v83, s88
  v_dot2_f32_bf16 v38, v28, v14, v38
  v_dot2_f32_bf16 v39, v29, v14, v39
  v_perm_b32 v26, v92, v88, s87
  v_perm_b32 v27, v92, v88, s88
  v_dot2_f32_bf16 v32, v26, v15, v32
  v_dot2_f32_bf16 v33, v27, v15, v33
  v_perm_b32 v28, v93, v89, s87
  v_perm_b32 v29, v93, v89, s88
  v_dot2_f32_bf16 v34, v28, v15, v34
  v_dot2_f32_bf16 v35, v29, v15, v35
  v_perm_b32 v26, v94, v90, s87
  v_perm_b32 v27, v94, v90, s88
  v_dot2_f32_bf16 v36, v26, v15, v36
  v_dot2_f32_bf16 v37, v27, v15, v37
  v_perm_b32 v28, v95, v91, s87
  v_perm_b32 v29, v95, v91, s88
  v_dot2_f32_bf16 v38, v28, v15, v38
  v_dot2_f32_bf16 v39, v29, v15, v39
  s_waitcnt vmcnt(20)
  v_perm_b32 v26, v100, v96, s87
  v_perm_b32 v27, v100, v96, s88
  v_dot2_f32_bf16 v32, v26, v16, v32
  v_dot2_f32_bf16 v33, v27, v16, v33
  v_perm_b32 v28, v101, v97, s87
  v_perm_b32 v29, v101, v97, s88
  v_dot2_f32_bf16 v34, v28, v16, v34
  v_dot2_f32_bf16 v35, v29, v16, v35
  v_perm_b32 v26, v102, v98, s87
  v_perm_b32 v27, v102, v98, s88
  v_dot2_f32_bf16 v36, v26, v16, v36
  v_dot2_f32_bf16 v37, v27, v16, v37
  v_perm_b32 v28, v103, v99, s87
  v_perm_b32 v29, v103, v99, s88
  v_dot2_f32_bf16 v38, v28, v16, v38
  v_dot2_f32_bf16 v39, v29, v16, v39
  v_perm_b32 v26, v108, v104, s87
  v_perm_b32 v27, v108, v104, s88
  v_dot2_f32_bf16 v32, v26, v17, v32
  v_dot2_f32_bf16 v33, v27, v17, v33
  v_perm_b32 v28, v109, v105, s87
  v_perm_b32 v29, v109, v105, s88
  v_dot2_f32_bf16 v34, v28, v17, v34
  v_dot2_f32_bf16 v35, v29, v17, v35
  v_perm_b32 v26, v110, v106, s87
  v_perm_b32 v27, v110, v106, s88
  v_dot2_f32_bf16 v36, v26, v17, v36
  v_dot2_f32_bf16 v37, v27, v17, v37
  v_perm_b32 v28, v111, v107, s87
  v_perm_b32 v29, v111, v107, s88
  v_dot2_f32_bf16 v38, v28, v17, v38
  v_dot2_f32_bf16 v39, v29, v17, v39
  s_waitcnt vmcnt(16)
  v_perm_b32 v26, v116, v112, s87
  v_perm_b32 v27, v116, v112, s88
  v_dot2_f32_bf16 v32, v26, v18, v32
  v_dot2_f32_bf16 v33, v27, v18, v33
  v_perm_b32 v28, v117, v113, s87
  v_perm_b32 v29, v117, v113, s88
  v_dot2_f32_bf16 v34, v28, v18, v34
  v_dot2_f32_bf16 v35, v29, v18, v35
  v_perm_b32 v26, v118, v114, s87
  v_perm_b32 v27, v118, v114, s88
  v_dot2_f32_bf16 v36, v26, v18, v36
  v_dot2_f32_bf16 v37, v27, v18, v37
  v_perm_b32 v28, v119, v115, s87
  v_perm_b32 v29, v119, v115, s88
  v_dot2_f32_bf16 v38, v28, v18, v38
  v_dot2_f32_bf16 v39, v29, v18, v39
  v_perm_b32 v26, v124, v120, s87
  v_perm_b32 v27, v124, v120, s88
  v_dot2_f32_bf16 v32, v26, v19, v32
  v_dot2_f32_bf16 v33, v27, v19, v33
  v_perm_b32 v28, v125, v121, s87
  v_perm_b32 v29, v125, v121, s88
  v_dot2_f32_bf16 v34, v28, v19, v34
  v_dot2_f32_bf16 v35, v29, v19, v35
  v_perm_b32 v26, v126, v122, s87
  v_perm_b32 v27, v126, v122, s88
  v_dot2_f32_bf16 v36, v26, v19, v36
  v_dot2_f32_bf16 v37, v27, v19, v37
  v_perm_b32 v28, v127, v123, s87
  v_perm_b32 v29, v127, v123, s88
  v_dot2_f32_bf16 v38, v28, v19, v38
  v_dot2_f32_bf16 v39, v29, v19, v39
  s_nop 0
  s_nop 1
  v_permlane32_swap_b32 v32, v36
  v_permlane32_swap_b32 v33, v37
  v_permlane32_swap_b32 v34, v38
  v_permlane32_swap_b32 v35, v39
  s_nop 0
  v_add_f32 v32, v32, v36
  v_add_f32 v33, v33, v37
  v_add_f32 v34, v34, v38
  v_add_f32 v35, v35, v39
  s_nop 1
  v_permlane16_swap_b32 v32, v34
  v_permlane16_swap_b32 v33, v35
  s_nop 0
  v_add_f32 v32, v32, v34
  v_add_f32 v33, v33, v35
  s_lshl_b32 s83, s74, 9
  v_add_u32 v26, s83, v61
  ds_write_b64 v26, v[32:33] offset:1024
  v_lshlrev_b32 v27, 5, v4
  buffer_load_dwordx4 v[224:227], v2, s[28:31], s75 offen offset:0 nt
  buffer_load_dwordx4 v[228:231], v2, s[28:31], s75 offen offset:1024 nt
  buffer_load_dwordx4 v[232:235], v2, s[28:31], s75 offen offset:2048 nt
  buffer_load_dwordx4 v[236:239], v2, s[28:31], s75 offen offset:3072 nt
  buffer_load_dwordx4 v[240:243], v2, s[32:35], s75 offen offset:0 nt
  buffer_load_dwordx4 v[244:247], v2, s[32:35], s75 offen offset:1024 nt
  buffer_load_dwordx4 v[248:251], v2, s[32:35], s75 offen offset:2048 nt
  buffer_load_dwordx4 v[252:255], v2, s[32:35], s75 offen offset:3072 nt
  s_add_u32 s75, s75, 32768
  s_waitcnt lgkmcnt(0)
  s_barrier
  ds_read_b128 v[64:67], v27 offset:1024
  ds_read_b128 v[68:71], v27 offset:1040
  ds_read_b128 v[72:75], v27 offset:1536
  ds_read_b128 v[76:79], v27 offset:1552
  ds_read_b128 v[80:83], v27 offset:2048
  ds_read_b128 v[84:87], v27 offset:2064
  ds_read_b128 v[88:91], v27 offset:2560
  ds_read_b128 v[92:95], v27 offset:2576
  ds_read_b128 v[96:99], v27 offset:3072
  ds_read_b128 v[100:103], v27 offset:3088
  ds_read_b128 v[104:107], v27 offset:3584
  ds_read_b128 v[108:111], v27 offset:3600
  ds_read_b128 v[112:115], v27 offset:4096
  ds_read_b128 v[116:119], v27 offset:4112
  ds_read_b128 v[120:123], v27 offset:4608
  ds_read_b128 v[124:127], v27 offset:4624
  v_mov_b32 v20, 0xff800000
  v_mov_b32 v21, 0
  v_mov_b32 v12, 0
  v_mov_b32 v13, 0
  v_mov_b32 v14, 0
  v_mov_b32 v15, 0
  v_mov_b32 v16, 0
  v_mov_b32 v17, 0
  v_mov_b32 v18, 0
  v_mov_b32 v19, 0
  s_lshl_b32 s83, s74, 11
  v_add_u32 v7, s83, v7
  s_waitcnt lgkmcnt(0)
  v_add_f32 v64, v64, v72
  v_add_f32 v65, v65, v73
  v_add_f32 v66, v66, v74
  v_add_f32 v67, v67, v75
  v_add_f32 v68, v68, v76
  v_add_f32 v69, v69, v77
  v_add_f32 v70, v70, v78
  v_add_f32 v71, v71, v79
  v_add_f32 v80, v80, v88
  v_add_f32 v81, v81, v89
  v_add_f32 v82, v82, v90
  v_add_f32 v83, v83, v91
  v_add_f32 v84, v84, v92
  v_add_f32 v85, v85, v93
  v_add_f32 v86, v86, v94
  v_add_f32 v87, v87, v95
  v_add_f32 v96, v96, v104
  v_add_f32 v97, v97, v105
  v_add_f32 v98, v98, v106
  v_add_f32 v99, v99, v107
  v_add_f32 v100, v100, v108
  v_add_f32 v101, v101, v109
  v_add_f32 v102, v102, v110
  v_add_f32 v103, v103, v111
  v_add_f32 v112, v112, v120
  v_add_f32 v113, v113, v121
  v_add_f32 v114, v114, v122
  v_add_f32 v115, v115, v123
  v_add_f32 v116, v116, v124
  v_add_f32 v117, v117, v125
  v_add_f32 v118, v118, v126
  v_add_f32 v119, v119, v127
  v_add_f32 v64, v64, v80
  v_add_f32 v65, v65, v81
  v_add_f32 v66, v66, v82
  v_add_f32 v67, v67, v83
  v_add_f32 v68, v68, v84
  v_add_f32 v69, v69, v85
  v_add_f32 v70, v70, v86
  v_add_f32 v71, v71, v87
  v_add_f32 v96, v96, v112
  v_add_f32 v97, v97, v113
  v_add_f32 v98, v98, v114
  v_add_f32 v99, v99, v115
  v_add_f32 v100, v100, v116
  v_add_f32 v101, v101, v117
  v_add_f32 v102, v102, v118
  v_add_f32 v103, v103, v119
  v_add_f32 v64, v64, v96
  v_add_f32 v65, v65, v97
  v_add_f32 v66, v66, v98
  v_add_f32 v67, v67, v99
  v_add_f32 v68, v68, v100
  v_add_f32 v69, v69, v101
  v_add_f32 v70, v70, v102
  v_add_f32 v71, v71, v103
  v_cvt_pk_bf16_f32 v8, v64, v65
  v_cvt_pk_bf16_f32 v9, v66, v67
  v_cvt_pk_bf16_f32 v10, v68, v69
  v_cvt_pk_bf16_f32 v11, v70, v71
  v_dot2_f32_bf16 v22, v128, v8, 0
  v_dot2_f32_bf16 v23, v132, v8, 0
  v_dot2_f32_bf16 v24, v136, v8, 0
  v_dot2_f32_bf16 v25, v140, v8, 0
  v_dot2_f32_bf16 v22, v129, v9, v22
  v_dot2_f32_bf16 v23, v133, v9, v23
  v_dot2_f32_bf16 v24, v137, v9, v24
  v_dot2_f32_bf16 v25, v141, v9, v25
  v_dot2_f32_bf16 v22, v130, v10, v22
  v_dot2_f32_bf16 v23, v134, v10, v23
  v_dot2_f32_bf16 v24, v138, v10, v24
  v_dot2_f32_bf16 v25, v142, v10, v25
  v_dot2_f32_bf16 v22, v131, v11, v22
  v_dot2_f32_bf16 v23, v135, v11, v23
  v_dot2_f32_bf16 v24, v139, v11, v24
  v_dot2_f32_bf16 v25, v143, v11, v25
  v_add_f32_dpp v22, v22, v22 row_ror:8 row_mask:0xf bank_mask:0xf
  v_add_f32_dpp v23, v23, v23 row_ror:8 row_mask:0xf bank_mask:0xf
  v_add_f32_dpp v24, v24, v24 row_ror:8 row_mask:0xf bank_mask:0xf
  v_add_f32_dpp v25, v25, v25 row_ror:8 row_mask:0xf bank_mask:0xf
  v_add_f32_dpp v22, v22, v22 row_ror:4 row_mask:0xf bank_mask:0xf
  v_add_f32_dpp v23, v23, v23 row_ror:4 row_mask:0xf bank_mask:0xf
  v_add_f32_dpp v24, v24, v24 row_ror:4 row_mask:0xf bank_mask:0xf
  v_add_f32_dpp v25, v25, v25 row_ror:4 row_mask:0xf bank_mask:0xf
  v_add_f32_dpp v22, v22, v22 row_ror:2 row_mask:0xf bank_mask:0xf
  v_add_f32_dpp v23, v23, v23 row_ror:2 row_mask:0xf bank_mask:0xf
  v_add_f32_dpp v24, v24, v24 row_ror:2 row_mask:0xf bank_mask:0xf
  v_add_f32_dpp v25, v25, v25 row_ror:2 row_mask:0xf bank_mask:0xf
  v_add_f32_dpp v22, v22, v22 row_ror:1 row_mask:0xf bank_mask:0xf
  v_add_f32_dpp v23, v23, v23 row_ror:1 row_mask:0xf bank_mask:0xf
  v_add_f32_dpp v24, v24, v24 row_ror:1 row_mask:0xf bank_mask:0xf
  v_add_f32_dpp v25, v25, v25 row_ror:1 row_mask:0xf bank_mask:0xf
  v_cvt_pk_bf16_f32 v40, v22, v23
  v_cvt_pk_bf16_f32 v41, v24, v25
  v_lshlrev_b32 v22, 16, v40
  v_and_b32 v23, s80, v40
  v_lshlrev_b32 v24, 16, v41
  v_and_b32 v25, s80, v41
  v_mul_f32 v22, s78, v22
  v_mul_f32 v23, s78, v23
  v_mul_f32 v24, s78, v24
  v_mul_f32 v25, s78, v25
  v_cvt_pk_bf16_f32 v40, v22, v23
  v_cvt_pk_bf16_f32 v41, v24, v25
  v_lshlrev_b32 v22, 16, v40
  v_and_b32 v23, s80, v40
  v_lshlrev_b32 v24, 16, v41
  v_and_b32 v25, s80, v41
  v_max3_f32 v42, v20, v22, v23
  v_max3_f32 v42, v42, v24, v25
  v_sub_f32 v44, v20, v42
  v_mul_f32 v43, s79, v42
  v_mul_f32 v44, s79, v44
  v_fma_f32 v32, v22, s79, -v43
  v_fma_f32 v33, v23, s79, -v43
  v_fma_f32 v34, v24, s79, -v43
  v_fma_f32 v35, v25, s79, -v43
  v_exp_f32 v44, v44
  v_exp_f32 v32, v32
  v_exp_f32 v33, v33
  v_exp_f32 v34, v34
  v_exp_f32 v35, v35
  v_mov_b32 v20, v42
  v_perm_b32 v128, v148, v144, s87
  v_perm_b32 v129, v148, v144, s88
  v_perm_b32 v130, v149, v145, s87
  v_perm_b32 v131, v149, v145, s88
  v_perm_b32 v132, v150, v146, s87
  v_perm_b32 v133, v150, v146, s88
  v_perm_b32 v134, v151, v147, s87
  v_perm_b32 v135, v151, v147, s88
  v_perm_b32 v136, v156, v152, s87
  v_perm_b32 v137, v156, v152, s88
  v_perm_b32 v138, v157, v153, s87
  v_perm_b32 v139, v157, v153, s88
  v_perm_b32 v140, v158, v154, s87
  v_perm_b32 v141, v158, v154, s88
  v_perm_b32 v142, v159, v155, s87
  v_perm_b32 v143, v159, v155, s88
  v_mul_f32 v21, v21, v44
  v_pk_mul_f32 v[12:13], v[12:13], v[44:45] op_sel_hi:[1,0]
  v_pk_mul_f32 v[14:15], v[14:15], v[44:45] op_sel_hi:[1,0]
  v_pk_mul_f32 v[16:17], v[16:17], v[44:45] op_sel_hi:[1,0]
  v_pk_mul_f32 v[18:19], v[18:19], v[44:45] op_sel_hi:[1,0]
  v_cvt_pk_bf16_f32 v36, v32, v33
  v_cvt_pk_bf16_f32 v37, v34, v35
  v_add_f32 v40, v32, v33
  v_add_f32 v41, v34, v35
  v_add_f32 v40, v40, v41
  v_add_f32 v21, v21, v40
  v_dot2_f32_bf16 v12, v128, v36, v12
  v_dot2_f32_bf16 v13, v129, v36, v13
  v_dot2_f32_bf16 v14, v130, v36, v14
  v_dot2_f32_bf16 v15, v131, v36, v15
  v_dot2_f32_bf16 v16, v132, v36, v16
  v_dot2_f32_bf16 v17, v133, v36, v17
  v_dot2_f32_bf16 v18, v134, v36, v18
  v_dot2_f32_bf16 v19, v135, v36, v19
  v_dot2_f32_bf16 v12, v136, v37, v12
  v_dot2_f32_bf16 v13, v137, v37, v13
  v_dot2_f32_bf16 v14, v138, v37, v14
  v_dot2_f32_bf16 v15, v139, v37, v15
  v_dot2_f32_bf16 v16, v140, v37, v16
  v_dot2_f32_bf16 v17, v141, v37, v17
  v_dot2_f32_bf16 v18, v142, v37, v18
  v_dot2_f32_bf16 v19, v143, v37, v19
  s_barrier
  v_mov_b32 v28, -1
  v_mov_b32 v29, -1
  v_mov_b32 v30, -1
  v_mov_b32 v31, -1
  v_and_b32 v62, 7, v1
  v_lshrrev_b32 v63, 2, v62
  v_lshlrev_b32 v63, 15, v63
  v_and_b32 v62, 3, v62
  v_lshl_add_u32 v63, v62, 5, v63
  v_and_b32 v62, 1, v3
  v_lshl_add_u32 v63, v62, 3, v63
  v_lshrrev_b32 v62, 1, v3
  v_lshl_add_u32 v63, v62, 4, v63
  s_lshl_b32 s83, s74, 16
  s_lshl_b32 s84, s82, 7
  s_add_u32 s83, s83, s84
  s_add_u32 s83, s83, 524288
  v_and_b32 v62, 8, v1
  v_cmp_eq_u32 vcc, 0, v62
  s_cmp_eq_u32 s86, 0
  s_cbranch_scc1 L_skip_gclr
  s_and_saveexec_b64 s[96:97], vcc
  buffer_store_dwordx2 v[28:29], v63, s[60:63], s83 offen sc0 sc1
  s_mov_b64 exec, s[96:97]
L_skip_gclr:
  s_cmp_lg_u32 s74, 0
  s_cbranch_scc1 L_skip_yclr
  v_lshrrev_b32 v62, 3, v1
  v_lshlrev_b32 v62, 15, v62
  v_and_b32 v63, 7, v1
  v_lshl_add_u32 v62, v63, 4, v62
  s_lshl_b32 s83, s81, 7
  s_add_u32 s84, s83, 262144
  buffer_store_dwordx4 v[28:31], v62, s[60:63], s83 offen sc0 sc1
  buffer_store_dwordx4 v[28:31], v62, s[60:63], s84 offen sc0 sc1
  s_lshl_b32 s84, s81, 3
  s_add_u32 s84, s84, 1048576
  v_mov_b32 v63, 0
  s_mov_b64 exec, 1
  buffer_store_dwordx2 v[28:29], v63, s[60:63], s84 offen sc0 sc1
  s_mov_b64 exec, -1
L_skip_yclr:
  buffer_load_dwordx4 v[128:131], v2, s[28:31], s75 offen offset:0 nt
  buffer_load_dwordx4 v[132:135], v2, s[28:31], s75 offen offset:1024 nt
  buffer_load_dwordx4 v[136:139], v2, s[28:31], s75 offen offset:2048 nt
  buffer_load_dwordx4 v[140:143], v2, s[28:31], s75 offen offset:3072 nt
  buffer_load_dwordx4 v[144:147], v2, s[32:35], s75 offen offset:0 nt
  buffer_load_dwordx4 v[148:151], v2, s[32:35], s75 offen offset:1024 nt
  buffer_load_dwordx4 v[152:155], v2, s[32:35], s75 offen offset:2048 nt
  buffer_load_dwordx4 v[156:159], v2, s[32:35], s75 offen offset:3072 nt
  s_add_u32 s75, s75, 32768
  s_add_u32 s85, s73, 0
  s_and_b32 s85, s85, 7
  s_lshl_b32 s85, s85, 14
  buffer_load_dwordx4 v[64:67], v7, s[40:43], s85 offen
  buffer_load_dwordx4 v[68:71], v7, s[40:43], s85 offen offset:1024
  s_waitcnt vmcnt(26)
  v_dot2_f32_bf16 v22, v160, v8, 0
  v_dot2_f32_bf16 v23, v164, v8, 0
  v_dot2_f32_bf16 v24, v168, v8, 0
  v_dot2_f32_bf16 v25, v172, v8, 0
  v_dot2_f32_bf16 v22, v161, v9, v22
  v_dot2_f32_bf16 v23, v165, v9, v23
  v_dot2_f32_bf16 v24, v169, v9, v24
  v_dot2_f32_bf16 v25, v173, v9, v25
  v_dot2_f32_bf16 v22, v162, v10, v22
  v_dot2_f32_bf16 v23, v166, v10, v23
  v_dot2_f32_bf16 v24, v170, v10, v24
  v_dot2_f32_bf16 v25, v174, v10, v25
  v_dot2_f32_bf16 v22, v163, v11, v22
  v_dot2_f32_bf16 v23, v167, v11, v23
  v_dot2_f32_bf16 v24, v171, v11, v24
  v_dot2_f32_bf16 v25, v175, v11, v25
  v_add_f32_dpp v22, v22, v22 row_ror:8 row_mask:0xf bank_mask:0xf
  v_add_f32_dpp v23, v23, v23 row_ror:8 row_mask:0xf bank_mask:0xf
  v_add_f32_dpp v24, v24, v24 row_ror:8 row_mask:0xf bank_mask:0xf
  v_add_f32_dpp v25, v25, v25 row_ror:8 row_mask:0xf bank_mask:0xf
  v_add_f32_dpp v22, v22, v22 row_ror:4 row_mask:0xf bank_mask:0xf
  v_add_f32_dpp v23, v23, v23 row_ror:4 row_mask:0xf bank_mask:0xf
  v_add_f32_dpp v24, v24, v24 row_ror:4 row_mask:0xf bank_mask:0xf
  v_add_f32_dpp v25, v25, v25 row_ror:4 row_mask:0xf bank_mask:0xf
  v_add_f32_dpp v22, v22, v22 row_ror:2 row_mask:0xf bank_mask:0xf
  v_add_f32_dpp v23, v23, v23 row_ror:2 row_mask:0xf bank_mask:0xf
  v_add_f32_dpp v24, v24, v24 row_ror:2 row_mask:0xf bank_mask:0xf
  v_add_f32_dpp v25, v25, v25 row_ror:2 row_mask:0xf bank_mask:0xf
  v_add_f32_dpp v22, v22, v22 row_ror:1 row_mask:0xf bank_mask:0xf
  v_add_f32_dpp v23, v23, v23 row_ror:1 row_mask:0xf bank_mask:0xf
  v_add_f32_dpp v24, v24, v24 row_ror:1 row_mask:0xf bank_mask:0xf
  v_add_f32_dpp v25, v25, v25 row_ror:1 row_mask:0xf bank_mask:0xf
  v_cvt_pk_bf16_f32 v40, v22, v23
  v_cvt_pk_bf16_f32 v41, v24, v25
  v_lshlrev_b32 v22, 16, v40
  v_and_b32 v23, s80, v40
  v_lshlrev_b32 v24, 16, v41
  v_and_b32 v25, s80, v41
  v_mul_f32 v22, s78, v22
  v_mul_f32 v23, s78, v23
  v_mul_f32 v24, s78, v24
  v_mul_f32 v25, s78, v25
  v_cvt_pk_bf16_f32 v40, v22, v23
  v_cvt_pk_bf16_f32 v41, v24, v25
  v_lshlrev_b32 v22, 16, v40
  v_and_b32 v23, s80, v40
  v_lshlrev_b32 v24, 16, v41
  v_and_b32 v25, s80, v41
  v_max3_f32 v42, v20, v22, v23
  v_max3_f32 v42, v42, v24, v25
  v_sub_f32 v44, v20, v42
  v_mul_f32 v43, s79, v42
  v_mul_f32 v44, s79, v44
  v_fma_f32 v32, v22, s79, -v43
  v_fma_f32 v33, v23, s79, -v43
  v_fma_f32 v34, v24, s79, -v43
  v_fma_f32 v35, v25, s79, -v43
  v_exp_f32 v44, v44
  v_exp_f32 v32, v32
  v_exp_f32 v33, v33
  v_exp_f32 v34, v34
  v_exp_f32 v35, v35
  v_mov_b32 v20, v42
  v_perm_b32 v160, v180, v176, s87
  v_perm_b32 v161, v180, v176, s88
  v_perm_b32 v162, v181, v177, s87
  v_perm_b32 v163, v181, v177, s88
  v_perm_b32 v164, v182, v178, s87
  v_perm_b32 v165, v182, v178, s88
  v_perm_b32 v166, v183, v179, s87
  v_perm_b32 v167, v183, v179, s88
  v_perm_b32 v168, v188, v184, s87
  v_perm_b32 v169, v188, v184, s88
  v_perm_b32 v170, v189, v185, s87
  v_perm_b32 v171, v189, v185, s88
  v_perm_b32 v172, v190, v186, s87
  v_perm_b32 v173, v190, v186, s88
  v_perm_b32 v174, v191, v187, s87
  v_perm_b32 v175, v191, v187, s88
  v_mul_f32 v21, v21, v44
  v_pk_mul_f32 v[12:13], v[12:13], v[44:45] op_sel_hi:[1,0]
  v_pk_mul_f32 v[14:15], v[14:15], v[44:45] op_sel_hi:[1,0]
  v_pk_mul_f32 v[16:17], v[16:17], v[44:45] op_sel_hi:[1,0]
  v_pk_mul_f32 v[18:19], v[18:19], v[44:45] op_sel_hi:[1,0]
  v_cvt_pk_bf16_f32 v36, v32, v33
  v_cvt_pk_bf16_f32 v37, v34, v35
  v_add_f32 v40, v32, v33
  v_add_f32 v41, v34, v35
  v_add_f32 v40, v40, v41
  v_add_f32 v21, v21, v40
  v_dot2_f32_bf16 v12, v160, v36, v12
  v_dot2_f32_bf16 v13, v161, v36, v13
  v_dot2_f32_bf16 v14, v162, v36, v14
  v_dot2_f32_bf16 v15, v163, v36, v15
  v_dot2_f32_bf16 v16, v164, v36, v16
  v_dot2_f32_bf16 v17, v165, v36, v17
  v_dot2_f32_bf16 v18, v166, v36, v18
  v_dot2_f32_bf16 v19, v167, v36, v19
  v_dot2_f32_bf16 v12, v168, v37, v12
  v_dot2_f32_bf16 v13, v169, v37, v13
  v_dot2_f32_bf16 v14, v170, v37, v14
  v_dot2_f32_bf16 v15, v171, v37, v15
  v_dot2_f32_bf16 v16, v172, v37, v16
  v_dot2_f32_bf16 v17, v173, v37, v17
  v_dot2_f32_bf16 v18, v174, v37, v18
  v_dot2_f32_bf16 v19, v175, v37, v19
  s_barrier
  buffer_load_dwordx4 v[160:163], v2, s[28:31], s75 offen offset:0 nt
  buffer_load_dwordx4 v[164:167], v2, s[28:31], s75 offen offset:1024 nt
  buffer_load_dwordx4 v[168:171], v2, s[28:31], s75 offen offset:2048 nt
  buffer_load_dwordx4 v[172:175], v2, s[28:31], s75 offen offset:3072 nt
  buffer_load_dwordx4 v[176:179], v2, s[32:35], s75 offen offset:0 nt
  buffer_load_dwordx4 v[180:183], v2, s[32:35], s75 offen offset:1024 nt
  buffer_load_dwordx4 v[184:187], v2, s[32:35], s75 offen offset:2048 nt
  buffer_load_dwordx4 v[188:191], v2, s[32:35], s75 offen offset:3072 nt
  s_add_u32 s75, s75, 32768
  s_movk_i32 s84, 3584
  v_mul_lo_u32 v62, v0, s84
  s_lshl_b32 s84, s82, 4
  buffer_load_dwordx4 v[46:49], v62, s[44:47], s84 offen
  buffer_load_dwordx4 v[50:53], v62, s[48:51], s84 offen
  v_lshrrev_b32 v63, 3, v1
  v_lshlrev_b32 v63, 10, v63
  v_and_b32 v59, 7, v1
  v_lshl_add_u32 v63, v59, 4, v63
  s_lshl_b32 s84, s82, 13
  s_lshl_b32 s83, s74, 7
  s_add_u32 s84, s84, s83
  buffer_load_dwordx4 v[54:57], v63, s[52:55], s84 offen nt
  s_waitcnt vmcnt(29)
  v_dot2_f32_bf16 v22, v192, v8, 0
  v_dot2_f32_bf16 v23, v196, v8, 0
  v_dot2_f32_bf16 v24, v200, v8, 0
  v_dot2_f32_bf16 v25, v204, v8, 0
  v_dot2_f32_bf16 v22, v193, v9, v22
  v_dot2_f32_bf16 v23, v197, v9, v23
  v_dot2_f32_bf16 v24, v201, v9, v24
  v_dot2_f32_bf16 v25, v205, v9, v25
  v_dot2_f32_bf16 v22, v194, v10, v22
  v_dot2_f32_bf16 v23, v198, v10, v23
  v_dot2_f32_bf16 v24, v202, v10, v24
  v_dot2_f32_bf16 v25, v206, v10, v25
  v_dot2_f32_bf16 v22, v195, v11, v22
  v_dot2_f32_bf16 v23, v199, v11, v23
  v_dot2_f32_bf16 v24, v203, v11, v24
  v_dot2_f32_bf16 v25, v207, v11, v25
  v_add_f32_dpp v22, v22, v22 row_ror:8 row_mask:0xf bank_mask:0xf
  v_add_f32_dpp v23, v23, v23 row_ror:8 row_mask:0xf bank_mask:0xf
  v_add_f32_dpp v24, v24, v24 row_ror:8 row_mask:0xf bank_mask:0xf
  v_add_f32_dpp v25, v25, v25 row_ror:8 row_mask:0xf bank_mask:0xf
  v_add_f32_dpp v22, v22, v22 row_ror:4 row_mask:0xf bank_mask:0xf
  v_add_f32_dpp v23, v23, v23 row_ror:4 row_mask:0xf bank_mask:0xf
  v_add_f32_dpp v24, v24, v24 row_ror:4 row_mask:0xf bank_mask:0xf
  v_add_f32_dpp v25, v25, v25 row_ror:4 row_mask:0xf bank_mask:0xf
  v_add_f32_dpp v22, v22, v22 row_ror:2 row_mask:0xf bank_mask:0xf
  v_add_f32_dpp v23, v23, v23 row_ror:2 row_mask:0xf bank_mask:0xf
  v_add_f32_dpp v24, v24, v24 row_ror:2 row_mask:0xf bank_mask:0xf
  v_add_f32_dpp v25, v25, v25 row_ror:2 row_mask:0xf bank_mask:0xf
  v_add_f32_dpp v22, v22, v22 row_ror:1 row_mask:0xf bank_mask:0xf
  v_add_f32_dpp v23, v23, v23 row_ror:1 row_mask:0xf bank_mask:0xf
  v_add_f32_dpp v24, v24, v24 row_ror:1 row_mask:0xf bank_mask:0xf
  v_add_f32_dpp v25, v25, v25 row_ror:1 row_mask:0xf bank_mask:0xf
  v_cvt_pk_bf16_f32 v40, v22, v23
  v_cvt_pk_bf16_f32 v41, v24, v25
  v_lshlrev_b32 v22, 16, v40
  v_and_b32 v23, s80, v40
  v_lshlrev_b32 v24, 16, v41
  v_and_b32 v25, s80, v41
  v_mul_f32 v22, s78, v22
  v_mul_f32 v23, s78, v23
  v_mul_f32 v24, s78, v24
  v_mul_f32 v25, s78, v25
  v_cvt_pk_bf16_f32 v40, v22, v23
  v_cvt_pk_bf16_f32 v41, v24, v25
  v_lshlrev_b32 v22, 16, v40
  v_and_b32 v23, s80, v40
  v_lshlrev_b32 v24, 16, v41
  v_and_b32 v25, s80, v41
  v_max3_f32 v42, v20, v22, v23
  v_max3_f32 v42, v42, v24, v25
  v_sub_f32 v44, v20, v42
  v_mul_f32 v43, s79, v42
  v_mul_f32 v44, s79, v44
  v_fma_f32 v32, v22, s79, -v43
  v_fma_f32 v33, v23, s79, -v43
  v_fma_f32 v34, v24, s79, -v43
  v_fma_f32 v35, v25, s79, -v43
  v_exp_f32 v44, v44
  v_exp_f32 v32, v32
  v_exp_f32 v33, v33
  v_exp_f32 v34, v34
  v_exp_f32 v35, v35
  v_mov_b32 v20, v42
  v_perm_b32 v192, v212, v208, s87
  v_perm_b32 v193, v212, v208, s88
  v_perm_b32 v194, v213, v209, s87
  v_perm_b32 v195, v213, v209, s88
  v_perm_b32 v196, v214, v210, s87
  v_perm_b32 v197, v214, v210, s88
  v_perm_b32 v198, v215, v211, s87
  v_perm_b32 v199, v215, v211, s88
  v_perm_b32 v200, v220, v216, s87
  v_perm_b32 v201, v220, v216, s88
  v_perm_b32 v202, v221, v217, s87
  v_perm_b32 v203, v221, v217, s88
  v_perm_b32 v204, v222, v218, s87
  v_perm_b32 v205, v222, v218, s88
  v_perm_b32 v206, v223, v219, s87
  v_perm_b32 v207, v223, v219, s88
  v_mul_f32 v21, v21, v44
  v_pk_mul_f32 v[12:13], v[12:13], v[44:45] op_sel_hi:[1,0]
  v_pk_mul_f32 v[14:15], v[14:15], v[44:45] op_sel_hi:[1,0]
  v_pk_mul_f32 v[16:17], v[16:17], v[44:45] op_sel_hi:[1,0]
  v_pk_mul_f32 v[18:19], v[18:19], v[44:45] op_sel_hi:[1,0]
  v_cvt_pk_bf16_f32 v36, v32, v33
  v_cvt_pk_bf16_f32 v37, v34, v35
  v_add_f32 v40, v32, v33
  v_add_f32 v41, v34, v35
  v_add_f32 v40, v40, v41
  v_add_f32 v21, v21, v40
  v_dot2_f32_bf16 v12, v192, v36, v12
  v_dot2_f32_bf16 v13, v193, v36, v13
  v_dot2_f32_bf16 v14, v194, v36, v14
  v_dot2_f32_bf16 v15, v195, v36, v15
  v_dot2_f32_bf16 v16, v196, v36, v16
  v_dot2_f32_bf16 v17, v197, v36, v17
  v_dot2_f32_bf16 v18, v198, v36, v18
  v_dot2_f32_bf16 v19, v199, v36, v19
  v_dot2_f32_bf16 v12, v200, v37, v12
  v_dot2_f32_bf16 v13, v201, v37, v13
  v_dot2_f32_bf16 v14, v202, v37, v14
  v_dot2_f32_bf16 v15, v203, v37, v15
  v_dot2_f32_bf16 v16, v204, v37, v16
  v_dot2_f32_bf16 v17, v205, v37, v17
  v_dot2_f32_bf16 v18, v206, v37, v18
  v_dot2_f32_bf16 v19, v207, v37, v19
  s_barrier
  buffer_load_dwordx4 v[192:195], v2, s[28:31], s75 offen offset:0 nt
  buffer_load_dwordx4 v[196:199], v2, s[28:31], s75 offen offset:1024 nt
  buffer_load_dwordx4 v[200:203], v2, s[28:31], s75 offen offset:2048 nt
  buffer_load_dwordx4 v[204:207], v2, s[28:31], s75 offen offset:3072 nt
  buffer_load_dwordx4 v[208:211], v2, s[32:35], s75 offen offset:0 nt
  buffer_load_dwordx4 v[212:215], v2, s[32:35], s75 offen offset:1024 nt
  buffer_load_dwordx4 v[216:219], v2, s[32:35], s75 offen offset:2048 nt
  buffer_load_dwordx4 v[220:223], v2, s[32:35], s75 offen offset:3072 nt
  s_add_u32 s75, s75, 32768
  s_waitcnt vmcnt(29)
  v_dot2_f32_bf16 v22, v224, v8, 0
  v_dot2_f32_bf16 v23, v228, v8, 0
  v_dot2_f32_bf16 v24, v232, v8, 0
  v_dot2_f32_bf16 v25, v236, v8, 0
  v_dot2_f32_bf16 v22, v225, v9, v22
  v_dot2_f32_bf16 v23, v229, v9, v23
  v_dot2_f32_bf16 v24, v233, v9, v24
  v_dot2_f32_bf16 v25, v237, v9, v25
  v_dot2_f32_bf16 v22, v226, v10, v22
  v_dot2_f32_bf16 v23, v230, v10, v23
  v_dot2_f32_bf16 v24, v234, v10, v24
  v_dot2_f32_bf16 v25, v238, v10, v25
  v_dot2_f32_bf16 v22, v227, v11, v22
  v_dot2_f32_bf16 v23, v231, v11, v23
  v_dot2_f32_bf16 v24, v235, v11, v24
  v_dot2_f32_bf16 v25, v239, v11, v25
  v_add_f32_dpp v22, v22, v22 row_ror:8 row_mask:0xf bank_mask:0xf
  v_add_f32_dpp v23, v23, v23 row_ror:8 row_mask:0xf bank_mask:0xf
  v_add_f32_dpp v24, v24, v24 row_ror:8 row_mask:0xf bank_mask:0xf
  v_add_f32_dpp v25, v25, v25 row_ror:8 row_mask:0xf bank_mask:0xf
  v_add_f32_dpp v22, v22, v22 row_ror:4 row_mask:0xf bank_mask:0xf
  v_add_f32_dpp v23, v23, v23 row_ror:4 row_mask:0xf bank_mask:0xf
  v_add_f32_dpp v24, v24, v24 row_ror:4 row_mask:0xf bank_mask:0xf
  v_add_f32_dpp v25, v25, v25 row_ror:4 row_mask:0xf bank_mask:0xf
  v_add_f32_dpp v22, v22, v22 row_ror:2 row_mask:0xf bank_mask:0xf
  v_add_f32_dpp v23, v23, v23 row_ror:2 row_mask:0xf bank_mask:0xf
  v_add_f32_dpp v24, v24, v24 row_ror:2 row_mask:0xf bank_mask:0xf
  v_add_f32_dpp v25, v25, v25 row_ror:2 row_mask:0xf bank_mask:0xf
  v_add_f32_dpp v22, v22, v22 row_ror:1 row_mask:0xf bank_mask:0xf
  v_add_f32_dpp v23, v23, v23 row_ror:1 row_mask:0xf bank_mask:0xf
  v_add_f32_dpp v24, v24, v24 row_ror:1 row_mask:0xf bank_mask:0xf
  v_add_f32_dpp v25, v25, v25 row_ror:1 row_mask:0xf bank_mask:0xf
  v_cvt_pk_bf16_f32 v40, v22, v23
  v_cvt_pk_bf16_f32 v41, v24, v25
  v_lshlrev_b32 v22, 16, v40
  v_and_b32 v23, s80, v40
  v_lshlrev_b32 v24, 16, v41
  v_and_b32 v25, s80, v41
  v_mul_f32 v22, s78, v22
  v_mul_f32 v23, s78, v23
  v_mul_f32 v24, s78, v24
  v_mul_f32 v25, s78, v25
  v_cvt_pk_bf16_f32 v40, v22, v23
  v_cvt_pk_bf16_f32 v41, v24, v25
  v_lshlrev_b32 v22, 16, v40
  v_and_b32 v23, s80, v40
  v_lshlrev_b32 v24, 16, v41
  v_and_b32 v25, s80, v41
  v_max3_f32 v42, v20, v22, v23
  v_max3_f32 v42, v42, v24, v25
  v_sub_f32 v44, v20, v42
  v_mul_f32 v43, s79, v42
  v_mul_f32 v44, s79, v44
  v_fma_f32 v32, v22, s79, -v43
  v_fma_f32 v33, v23, s79, -v43
  v_fma_f32 v34, v24, s79, -v43
  v_fma_f32 v35, v25, s79, -v43
  v_exp_f32 v44, v44
  v_exp_f32 v32, v32
  v_exp_f32 v33, v33
  v_exp_f32 v34, v34
  v_exp_f32 v35, v35
  v_mov_b32 v20, v42
  v_perm_b32 v224, v244, v240, s87
  v_perm_b32 v225, v244, v240, s88
  v_perm_b32 v226, v245, v241, s87
  v_perm_b32 v227, v245, v241, s88
  v_perm_b32 v228, v246, v242, s87
  v_perm_b32 v229, v246, v242, s88
  v_perm_b32 v230, v247, v243, s87
  v_perm_b32 v231, v247, v243, s88
  v_perm_b32 v232, v252, v248, s87
  v_perm_b32 v233, v252, v248, s88
  v_perm_b32 v234, v253, v249, s87
  v_perm_b32 v235, v253, v249, s88
  v_perm_b32 v236, v254, v250, s87
  v_perm_b32 v237, v254, v250, s88
  v_perm_b32 v238, v255, v251, s87
  v_perm_b32 v239, v255, v251, s88
  v_mul_f32 v21, v21, v44
  v_pk_mul_f32 v[12:13], v[12:13], v[44:45] op_sel_hi:[1,0]
  v_pk_mul_f32 v[14:15], v[14:15], v[44:45] op_sel_hi:[1,0]
  v_pk_mul_f32 v[16:17], v[16:17], v[44:45] op_sel_hi:[1,0]
  v_pk_mul_f32 v[18:19], v[18:19], v[44:45] op_sel_hi:[1,0]
  v_cvt_pk_bf16_f32 v36, v32, v33
  v_cvt_pk_bf16_f32 v37, v34, v35
  v_add_f32 v40, v32, v33
  v_add_f32 v41, v34, v35
  v_add_f32 v40, v40, v41
  v_add_f32 v21, v21, v40
  v_dot2_f32_bf16 v12, v224, v36, v12
  v_dot2_f32_bf16 v13, v225, v36, v13
  v_dot2_f32_bf16 v14, v226, v36, v14
  v_dot2_f32_bf16 v15, v227, v36, v15
  v_dot2_f32_bf16 v16, v228, v36, v16
  v_dot2_f32_bf16 v17, v229, v36, v17
  v_dot2_f32_bf16 v18, v230, v36, v18
  v_dot2_f32_bf16 v19, v231, v36, v19
  v_dot2_f32_bf16 v12, v232, v37, v12
  v_dot2_f32_bf16 v13, v233, v37, v13
  v_dot2_f32_bf16 v14, v234, v37, v14
  v_dot2_f32_bf16 v15, v235, v37, v15
  v_dot2_f32_bf16 v16, v236, v37, v16
  v_dot2_f32_bf16 v17, v237, v37, v17
  v_dot2_f32_bf16 v18, v238, v37, v18
  v_dot2_f32_bf16 v19, v239, v37, v19
  s_barrier
  buffer_load_dwordx4 v[224:227], v2, s[28:31], s75 offen offset:0 nt
  buffer_load_dwordx4 v[228:231], v2, s[28:31], s75 offen offset:1024 nt
  buffer_load_dwordx4 v[232:235], v2, s[28:31], s75 offen offset:2048 nt
  buffer_load_dwordx4 v[236:239], v2, s[28:31], s75 offen offset:3072 nt
  buffer_load_dwordx4 v[240:243], v2, s[32:35], s75 offen offset:0 nt
  buffer_load_dwordx4 v[244:247], v2, s[32:35], s75 offen offset:1024 nt
  buffer_load_dwordx4 v[248:251], v2, s[32:35], s75 offen offset:2048 nt
  buffer_load_dwordx4 v[252:255], v2, s[32:35], s75 offen offset:3072 nt
  s_add_u32 s75, s75, 32768
  s_add_u32 s85, s73, 1
  s_and_b32 s85, s85, 7
  s_lshl_b32 s85, s85, 14
  buffer_load_dwordx4 v[72:75], v7, s[40:43], s85 offen
  buffer_load_dwordx4 v[76:79], v7, s[40:43], s85 offen offset:1024
  s_add_u32 s85, s73, 2
  s_and_b32 s85, s85, 7
  s_lshl_b32 s85, s85, 14
  buffer_load_dwordx4 v[80:83], v7, s[40:43], s85 offen
  buffer_load_dwordx4 v[84:87], v7, s[40:43], s85 offen offset:1024
  s_waitcnt vmcnt(33)
  v_dot2_f32_bf16 v22, v128, v8, 0
  v_dot2_f32_bf16 v23, v132, v8, 0
  v_dot2_f32_bf16 v24, v136, v8, 0
  v_dot2_f32_bf16 v25, v140, v8, 0
  v_dot2_f32_bf16 v22, v129, v9, v22
  v_dot2_f32_bf16 v23, v133, v9, v23
  v_dot2_f32_bf16 v24, v137, v9, v24
  v_dot2_f32_bf16 v25, v141, v9, v25
  v_dot2_f32_bf16 v22, v130, v10, v22
  v_dot2_f32_bf16 v23, v134, v10, v23
  v_dot2_f32_bf16 v24, v138, v10, v24
  v_dot2_f32_bf16 v25, v142, v10, v25
  v_dot2_f32_bf16 v22, v131, v11, v22
  v_dot2_f32_bf16 v23, v135, v11, v23
  v_dot2_f32_bf16 v24, v139, v11, v24
  v_dot2_f32_bf16 v25, v143, v11, v25
  v_add_f32_dpp v22, v22, v22 row_ror:8 row_mask:0xf bank_mask:0xf
  v_add_f32_dpp v23, v23, v23 row_ror:8 row_mask:0xf bank_mask:0xf
  v_add_f32_dpp v24, v24, v24 row_ror:8 row_mask:0xf bank_mask:0xf
  v_add_f32_dpp v25, v25, v25 row_ror:8 row_mask:0xf bank_mask:0xf
  v_add_f32_dpp v22, v22, v22 row_ror:4 row_mask:0xf bank_mask:0xf
  v_add_f32_dpp v23, v23, v23 row_ror:4 row_mask:0xf bank_mask:0xf
  v_add_f32_dpp v24, v24, v24 row_ror:4 row_mask:0xf bank_mask:0xf
  v_add_f32_dpp v25, v25, v25 row_ror:4 row_mask:0xf bank_mask:0xf
  v_add_f32_dpp v22, v22, v22 row_ror:2 row_mask:0xf bank_mask:0xf
  v_add_f32_dpp v23, v23, v23 row_ror:2 row_mask:0xf bank_mask:0xf
  v_add_f32_dpp v24, v24, v24 row_ror:2 row_mask:0xf bank_mask:0xf
  v_add_f32_dpp v25, v25, v25 row_ror:2 row_mask:0xf bank_mask:0xf
  v_add_f32_dpp v22, v22, v22 row_ror:1 row_mask:0xf bank_mask:0xf
  v_add_f32_dpp v23, v23, v23 row_ror:1 row_mask:0xf bank_mask:0xf
  v_add_f32_dpp v24, v24, v24 row_ror:1 row_mask:0xf bank_mask:0xf
  v_add_f32_dpp v25, v25, v25 row_ror:1 row_mask:0xf bank_mask:0xf
  v_cvt_pk_bf16_f32 v40, v22, v23
  v_cvt_pk_bf16_f32 v41, v24, v25
  v_lshlrev_b32 v22, 16, v40
  v_and_b32 v23, s80, v40
  v_lshlrev_b32 v24, 16, v41
  v_and_b32 v25, s80, v41
  v_mul_f32 v22, s78, v22
  v_mul_f32 v23, s78, v23
  v_mul_f32 v24, s78, v24
  v_mul_f32 v25, s78, v25
  v_cvt_pk_bf16_f32 v40, v22, v23
  v_cvt_pk_bf16_f32 v41, v24, v25
  v_lshlrev_b32 v22, 16, v40
  v_and_b32 v23, s80, v40
  v_lshlrev_b32 v24, 16, v41
  v_and_b32 v25, s80, v41
  v_max3_f32 v42, v20, v22, v23
  v_max3_f32 v42, v42, v24, v25
  v_sub_f32 v44, v20, v42
  v_mul_f32 v43, s79, v42
  v_mul_f32 v44, s79, v44
  v_fma_f32 v32, v22, s79, -v43
  v_fma_f32 v33, v23, s79, -v43
  v_fma_f32 v34, v24, s79, -v43
  v_fma_f32 v35, v25, s79, -v43
  v_exp_f32 v44, v44
  v_exp_f32 v32, v32
  v_exp_f32 v33, v33
  v_exp_f32 v34, v34
  v_exp_f32 v35, v35
  v_mov_b32 v20, v42
  v_perm_b32 v128, v148, v144, s87
  v_perm_b32 v129, v148, v144, s88
  v_perm_b32 v130, v149, v145, s87
  v_perm_b32 v131, v149, v145, s88
  v_perm_b32 v132, v150, v146, s87
  v_perm_b32 v133, v150, v146, s88
  v_perm_b32 v134, v151, v147, s87
  v_perm_b32 v135, v151, v147, s88
  v_perm_b32 v136, v156, v152, s87
  v_perm_b32 v137, v156, v152, s88
  v_perm_b32 v138, v157, v153, s87
  v_perm_b32 v139, v157, v153, s88
  v_perm_b32 v140, v158, v154, s87
  v_perm_b32 v141, v158, v154, s88
  v_perm_b32 v142, v159, v155, s87
  v_perm_b32 v143, v159, v155, s88
  v_mul_f32 v21, v21, v44
  v_pk_mul_f32 v[12:13], v[12:13], v[44:45] op_sel_hi:[1,0]
  v_pk_mul_f32 v[14:15], v[14:15], v[44:45] op_sel_hi:[1,0]
  v_pk_mul_f32 v[16:17], v[16:17], v[44:45] op_sel_hi:[1,0]
  v_pk_mul_f32 v[18:19], v[18:19], v[44:45] op_sel_hi:[1,0]
  v_cvt_pk_bf16_f32 v36, v32, v33
  v_cvt_pk_bf16_f32 v37, v34, v35
  v_add_f32 v40, v32, v33
  v_add_f32 v41, v34, v35
  v_add_f32 v40, v40, v41
  v_add_f32 v21, v21, v40
  v_dot2_f32_bf16 v12, v128, v36, v12
  v_dot2_f32_bf16 v13, v129, v36, v13
  v_dot2_f32_bf16 v14, v130, v36, v14
  v_dot2_f32_bf16 v15, v131, v36, v15
  v_dot2_f32_bf16 v16, v132, v36, v16
  v_dot2_f32_bf16 v17, v133, v36, v17
  v_dot2_f32_bf16 v18, v134, v36, v18
  v_dot2_f32_bf16 v19, v135, v36, v19
  v_dot2_f32_bf16 v12, v136, v37, v12
  v_dot2_f32_bf16 v13, v137, v37, v13
  v_dot2_f32_bf16 v14, v138, v37, v14
  v_dot2_f32_bf16 v15, v139, v37, v15
  v_dot2_f32_bf16 v16, v140, v37, v16
  v_dot2_f32_bf16 v17, v141, v37, v17
  v_dot2_f32_bf16 v18, v142, v37, v18
  v_dot2_f32_bf16 v19, v143, v37, v19
  s_barrier
  s_cmp_lg_u32 s74, 0
  s_cbranch_scc1 L_skip_sig
  v_mov_b32 v62, 1
  v_mov_b32 v63, 0
  s_mov_b64 exec, 1
  buffer_atomic_add v62, v63, s[68:71], s90 offen
  s_mov_b64 exec, -1
L_skip_sig:
  buffer_load_dwordx4 v[128:131], v2, s[28:31], s75 offen offset:0 nt
  buffer_load_dwordx4 v[132:135], v2, s[28:31], s75 offen offset:1024 nt
  buffer_load_dwordx4 v[136:139], v2, s[28:31], s75 offen offset:2048 nt
  buffer_load_dwordx4 v[140:143], v2, s[28:31], s75 offen offset:3072 nt
  buffer_load_dwordx4 v[144:147], v2, s[32:35], s75 offen offset:0 nt
  buffer_load_dwordx4 v[148:151], v2, s[32:35], s75 offen offset:1024 nt
  buffer_load_dwordx4 v[152:155], v2, s[32:35], s75 offen offset:2048 nt
  buffer_load_dwordx4 v[156:159], v2, s[32:35], s75 offen offset:3072 nt
  s_add_u32 s75, s75, 32768
  s_add_u32 s85, s73, 3
  s_and_b32 s85, s85, 7
  s_lshl_b32 s85, s85, 14
  buffer_load_dwordx4 v[88:91], v7, s[40:43], s85 offen
  buffer_load_dwordx4 v[92:95], v7, s[40:43], s85 offen offset:1024
  s_add_u32 s85, s73, 4
  s_and_b32 s85, s85, 7
  s_lshl_b32 s85, s85, 14
  buffer_load_dwordx4 v[96:99], v7, s[40:43], s85 offen
  buffer_load_dwordx4 v[100:103], v7, s[40:43], s85 offen offset:1024
  s_waitcnt vmcnt(35)
  v_dot2_f32_bf16 v22, v160, v8, 0
  v_dot2_f32_bf16 v23, v164, v8, 0
  v_dot2_f32_bf16 v24, v168, v8, 0
  v_dot2_f32_bf16 v25, v172, v8, 0
  v_dot2_f32_bf16 v22, v161, v9, v22
  v_dot2_f32_bf16 v23, v165, v9, v23
  v_dot2_f32_bf16 v24, v169, v9, v24
  v_dot2_f32_bf16 v25, v173, v9, v25
  v_dot2_f32_bf16 v22, v162, v10, v22
  v_dot2_f32_bf16 v23, v166, v10, v23
  v_dot2_f32_bf16 v24, v170, v10, v24
  v_dot2_f32_bf16 v25, v174, v10, v25
  v_dot2_f32_bf16 v22, v163, v11, v22
  v_dot2_f32_bf16 v23, v167, v11, v23
  v_dot2_f32_bf16 v24, v171, v11, v24
  v_dot2_f32_bf16 v25, v175, v11, v25
  v_add_f32_dpp v22, v22, v22 row_ror:8 row_mask:0xf bank_mask:0xf
  v_add_f32_dpp v23, v23, v23 row_ror:8 row_mask:0xf bank_mask:0xf
  v_add_f32_dpp v24, v24, v24 row_ror:8 row_mask:0xf bank_mask:0xf
  v_add_f32_dpp v25, v25, v25 row_ror:8 row_mask:0xf bank_mask:0xf
  v_add_f32_dpp v22, v22, v22 row_ror:4 row_mask:0xf bank_mask:0xf
  v_add_f32_dpp v23, v23, v23 row_ror:4 row_mask:0xf bank_mask:0xf
  v_add_f32_dpp v24, v24, v24 row_ror:4 row_mask:0xf bank_mask:0xf
  v_add_f32_dpp v25, v25, v25 row_ror:4 row_mask:0xf bank_mask:0xf
  v_add_f32_dpp v22, v22, v22 row_ror:2 row_mask:0xf bank_mask:0xf
  v_add_f32_dpp v23, v23, v23 row_ror:2 row_mask:0xf bank_mask:0xf
  v_add_f32_dpp v24, v24, v24 row_ror:2 row_mask:0xf bank_mask:0xf
  v_add_f32_dpp v25, v25, v25 row_ror:2 row_mask:0xf bank_mask:0xf
  v_add_f32_dpp v22, v22, v22 row_ror:1 row_mask:0xf bank_mask:0xf
  v_add_f32_dpp v23, v23, v23 row_ror:1 row_mask:0xf bank_mask:0xf
  v_add_f32_dpp v24, v24, v24 row_ror:1 row_mask:0xf bank_mask:0xf
  v_add_f32_dpp v25, v25, v25 row_ror:1 row_mask:0xf bank_mask:0xf
  v_cvt_pk_bf16_f32 v40, v22, v23
  v_cvt_pk_bf16_f32 v41, v24, v25
  v_lshlrev_b32 v22, 16, v40
  v_and_b32 v23, s80, v40
  v_lshlrev_b32 v24, 16, v41
  v_and_b32 v25, s80, v41
  v_mul_f32 v22, s78, v22
  v_mul_f32 v23, s78, v23
  v_mul_f32 v24, s78, v24
  v_mul_f32 v25, s78, v25
  v_cvt_pk_bf16_f32 v40, v22, v23
  v_cvt_pk_bf16_f32 v41, v24, v25
  v_lshlrev_b32 v22, 16, v40
  v_and_b32 v23, s80, v40
  v_lshlrev_b32 v24, 16, v41
  v_and_b32 v25, s80, v41
  v_max3_f32 v42, v20, v22, v23
  v_max3_f32 v42, v42, v24, v25
  v_sub_f32 v44, v20, v42
  v_mul_f32 v43, s79, v42
  v_mul_f32 v44, s79, v44
  v_fma_f32 v32, v22, s79, -v43
  v_fma_f32 v33, v23, s79, -v43
  v_fma_f32 v34, v24, s79, -v43
  v_fma_f32 v35, v25, s79, -v43
  v_exp_f32 v44, v44
  v_exp_f32 v32, v32
  v_exp_f32 v33, v33
  v_exp_f32 v34, v34
  v_exp_f32 v35, v35
  v_mov_b32 v20, v42
  v_perm_b32 v160, v180, v176, s87
  v_perm_b32 v161, v180, v176, s88
  v_perm_b32 v162, v181, v177, s87
  v_perm_b32 v163, v181, v177, s88
  v_perm_b32 v164, v182, v178, s87
  v_perm_b32 v165, v182, v178, s88
  v_perm_b32 v166, v183, v179, s87
  v_perm_b32 v167, v183, v179, s88
  v_perm_b32 v168, v188, v184, s87
  v_perm_b32 v169, v188, v184, s88
  v_perm_b32 v170, v189, v185, s87
  v_perm_b32 v171, v189, v185, s88
  v_perm_b32 v172, v190, v186, s87
  v_perm_b32 v173, v190, v186, s88
  v_perm_b32 v174, v191, v187, s87
  v_perm_b32 v175, v191, v187, s88
  v_mul_f32 v21, v21, v44
  v_pk_mul_f32 v[12:13], v[12:13], v[44:45] op_sel_hi:[1,0]
  v_pk_mul_f32 v[14:15], v[14:15], v[44:45] op_sel_hi:[1,0]
  v_pk_mul_f32 v[16:17], v[16:17], v[44:45] op_sel_hi:[1,0]
  v_pk_mul_f32 v[18:19], v[18:19], v[44:45] op_sel_hi:[1,0]
  v_cvt_pk_bf16_f32 v36, v32, v33
  v_cvt_pk_bf16_f32 v37, v34, v35
  v_add_f32 v40, v32, v33
  v_add_f32 v41, v34, v35
  v_add_f32 v40, v40, v41
  v_add_f32 v21, v21, v40
  v_dot2_f32_bf16 v12, v160, v36, v12
  v_dot2_f32_bf16 v13, v161, v36, v13
  v_dot2_f32_bf16 v14, v162, v36, v14
  v_dot2_f32_bf16 v15, v163, v36, v15
  v_dot2_f32_bf16 v16, v164, v36, v16
  v_dot2_f32_bf16 v17, v165, v36, v17
  v_dot2_f32_bf16 v18, v166, v36, v18
  v_dot2_f32_bf16 v19, v167, v36, v19
  v_dot2_f32_bf16 v12, v168, v37, v12
  v_dot2_f32_bf16 v13, v169, v37, v13
  v_dot2_f32_bf16 v14, v170, v37, v14
  v_dot2_f32_bf16 v15, v171, v37, v15
  v_dot2_f32_bf16 v16, v172, v37, v16
  v_dot2_f32_bf16 v17, v173, v37, v17
  v_dot2_f32_bf16 v18, v174, v37, v18
  v_dot2_f32_bf16 v19, v175, v37, v19
  s_barrier
  buffer_load_dwordx4 v[160:163], v2, s[28:31], s75 offen offset:0 nt
  buffer_load_dwordx4 v[164:167], v2, s[28:31], s75 offen offset:1024 nt
  buffer_load_dwordx4 v[168:171], v2, s[28:31], s75 offen offset:2048 nt
  buffer_load_dwordx4 v[172:175], v2, s[28:31], s75 offen offset:3072 nt
  buffer_load_dwordx4 v[176:179], v2, s[32:35], s75 offen offset:0 nt
  buffer_load_dwordx4 v[180:183], v2, s[32:35], s75 offen offset:1024 nt
  buffer_load_dwordx4 v[184:187], v2, s[32:35], s75 offen offset:2048 nt
  buffer_load_dwordx4 v[188:191], v2, s[32:35], s75 offen offset:3072 nt
  s_add_u32 s75, s75, 32768
  s_add_u32 s85, s73, 5
  s_and_b32 s85, s85, 7
  s_lshl_b32 s85, s85, 14
  buffer_load_dwordx4 v[104:107], v7, s[40:43], s85 offen
  buffer_load_dwordx4 v[108:111], v7, s[40:43], s85 offen offset:1024
  s_add_u32 s85, s73, 6
  s_and_b32 s85, s85, 7
  s_lshl_b32 s85, s85, 14
  buffer_load_dwordx4 v[112:115], v7, s[40:43], s85 offen
  buffer_load_dwordx4 v[116:119], v7, s[40:43], s85 offen offset:1024
  s_waitcnt vmcnt(36)
  v_dot2_f32_bf16 v22, v192, v8, 0
  v_dot2_f32_bf16 v23, v196, v8, 0
  v_dot2_f32_bf16 v24, v200, v8, 0
  v_dot2_f32_bf16 v25, v204, v8, 0
  v_dot2_f32_bf16 v22, v193, v9, v22
  v_dot2_f32_bf16 v23, v197, v9, v23
  v_dot2_f32_bf16 v24, v201, v9, v24
  v_dot2_f32_bf16 v25, v205, v9, v25
  v_dot2_f32_bf16 v22, v194, v10, v22
  v_dot2_f32_bf16 v23, v198, v10, v23
  v_dot2_f32_bf16 v24, v202, v10, v24
  v_dot2_f32_bf16 v25, v206, v10, v25
  v_dot2_f32_bf16 v22, v195, v11, v22
  v_dot2_f32_bf16 v23, v199, v11, v23
  v_dot2_f32_bf16 v24, v203, v11, v24
  v_dot2_f32_bf16 v25, v207, v11, v25
  v_add_f32_dpp v22, v22, v22 row_ror:8 row_mask:0xf bank_mask:0xf
  v_add_f32_dpp v23, v23, v23 row_ror:8 row_mask:0xf bank_mask:0xf
  v_add_f32_dpp v24, v24, v24 row_ror:8 row_mask:0xf bank_mask:0xf
  v_add_f32_dpp v25, v25, v25 row_ror:8 row_mask:0xf bank_mask:0xf
  v_add_f32_dpp v22, v22, v22 row_ror:4 row_mask:0xf bank_mask:0xf
  v_add_f32_dpp v23, v23, v23 row_ror:4 row_mask:0xf bank_mask:0xf
  v_add_f32_dpp v24, v24, v24 row_ror:4 row_mask:0xf bank_mask:0xf
  v_add_f32_dpp v25, v25, v25 row_ror:4 row_mask:0xf bank_mask:0xf
  v_add_f32_dpp v22, v22, v22 row_ror:2 row_mask:0xf bank_mask:0xf
  v_add_f32_dpp v23, v23, v23 row_ror:2 row_mask:0xf bank_mask:0xf
  v_add_f32_dpp v24, v24, v24 row_ror:2 row_mask:0xf bank_mask:0xf
  v_add_f32_dpp v25, v25, v25 row_ror:2 row_mask:0xf bank_mask:0xf
  v_add_f32_dpp v22, v22, v22 row_ror:1 row_mask:0xf bank_mask:0xf
  v_add_f32_dpp v23, v23, v23 row_ror:1 row_mask:0xf bank_mask:0xf
  v_add_f32_dpp v24, v24, v24 row_ror:1 row_mask:0xf bank_mask:0xf
  v_add_f32_dpp v25, v25, v25 row_ror:1 row_mask:0xf bank_mask:0xf
  v_cvt_pk_bf16_f32 v40, v22, v23
  v_cvt_pk_bf16_f32 v41, v24, v25
  v_lshlrev_b32 v22, 16, v40
  v_and_b32 v23, s80, v40
  v_lshlrev_b32 v24, 16, v41
  v_and_b32 v25, s80, v41
  v_mul_f32 v22, s78, v22
  v_mul_f32 v23, s78, v23
  v_mul_f32 v24, s78, v24
  v_mul_f32 v25, s78, v25
  v_cvt_pk_bf16_f32 v40, v22, v23
  v_cvt_pk_bf16_f32 v41, v24, v25
  v_lshlrev_b32 v22, 16, v40
  v_and_b32 v23, s80, v40
  v_lshlrev_b32 v24, 16, v41
  v_and_b32 v25, s80, v41
  v_max3_f32 v42, v20, v22, v23
  v_max3_f32 v42, v42, v24, v25
  v_sub_f32 v44, v20, v42
  v_mul_f32 v43, s79, v42
  v_mul_f32 v44, s79, v44
  v_fma_f32 v32, v22, s79, -v43
  v_fma_f32 v33, v23, s79, -v43
  v_fma_f32 v34, v24, s79, -v43
  v_fma_f32 v35, v25, s79, -v43
  v_exp_f32 v44, v44
  v_exp_f32 v32, v32
  v_exp_f32 v33, v33
  v_exp_f32 v34, v34
  v_exp_f32 v35, v35
  v_mov_b32 v20, v42
  v_perm_b32 v192, v212, v208, s87
  v_perm_b32 v193, v212, v208, s88
  v_perm_b32 v194, v213, v209, s87
  v_perm_b32 v195, v213, v209, s88
  v_perm_b32 v196, v214, v210, s87
  v_perm_b32 v197, v214, v210, s88
  v_perm_b32 v198, v215, v211, s87
  v_perm_b32 v199, v215, v211, s88
  v_perm_b32 v200, v220, v216, s87
  v_perm_b32 v201, v220, v216, s88
  v_perm_b32 v202, v221, v217, s87
  v_perm_b32 v203, v221, v217, s88
  v_perm_b32 v204, v222, v218, s87
  v_perm_b32 v205, v222, v218, s88
  v_perm_b32 v206, v223, v219, s87
  v_perm_b32 v207, v223, v219, s88
  v_mul_f32 v21, v21, v44
  v_pk_mul_f32 v[12:13], v[12:13], v[44:45] op_sel_hi:[1,0]
  v_pk_mul_f32 v[14:15], v[14:15], v[44:45] op_sel_hi:[1,0]
  v_pk_mul_f32 v[16:17], v[16:17], v[44:45] op_sel_hi:[1,0]
  v_pk_mul_f32 v[18:19], v[18:19], v[44:45] op_sel_hi:[1,0]
  v_cvt_pk_bf16_f32 v36, v32, v33
  v_cvt_pk_bf16_f32 v37, v34, v35
  v_add_f32 v40, v32, v33
  v_add_f32 v41, v34, v35
  v_add_f32 v40, v40, v41
  v_add_f32 v21, v21, v40
  v_dot2_f32_bf16 v12, v192, v36, v12
  v_dot2_f32_bf16 v13, v193, v36, v13
  v_dot2_f32_bf16 v14, v194, v36, v14
  v_dot2_f32_bf16 v15, v195, v36, v15
  v_dot2_f32_bf16 v16, v196, v36, v16
  v_dot2_f32_bf16 v17, v197, v36, v17
  v_dot2_f32_bf16 v18, v198, v36, v18
  v_dot2_f32_bf16 v19, v199, v36, v19
  v_dot2_f32_bf16 v12, v200, v37, v12
  v_dot2_f32_bf16 v13, v201, v37, v13
  v_dot2_f32_bf16 v14, v202, v37, v14
  v_dot2_f32_bf16 v15, v203, v37, v15
  v_dot2_f32_bf16 v16, v204, v37, v16
  v_dot2_f32_bf16 v17, v205, v37, v17
  v_dot2_f32_bf16 v18, v206, v37, v18
  v_dot2_f32_bf16 v19, v207, v37, v19
  v_lshlrev_b32 v26, 16, v46
  v_and_b32 v27, s80, v46
  v_lshlrev_b32 v28, 16, v47
  v_and_b32 v29, s80, v47
  v_lshlrev_b32 v30, 16, v48
  v_and_b32 v31, s80, v48
  v_lshlrev_b32 v58, 16, v49
  v_and_b32 v59, s80, v49
  v_mul_f32 v26, v26, v60
  v_mul_f32 v27, v27, v60
  v_mul_f32 v28, v28, v60
  v_mul_f32 v29, v29, v60
  v_mul_f32 v30, v30, v60
  v_mul_f32 v31, v31, v60
  v_mul_f32 v58, v58, v60
  v_mul_f32 v59, v59, v60
  s_nop 1
  v_permlane32_swap_b32 v26, v30
  v_permlane32_swap_b32 v27, v31
  v_permlane32_swap_b32 v28, v58
  v_permlane32_swap_b32 v29, v59
  s_nop 0
  v_add_f32 v26, v26, v30
  v_add_f32 v27, v27, v31
  v_add_f32 v28, v28, v58
  v_add_f32 v29, v29, v59
  s_nop 1
  v_permlane16_swap_b32 v26, v28
  v_permlane16_swap_b32 v27, v29
  s_nop 0
  v_add_f32 v26, v26, v28
  v_add_f32 v27, v27, v29
  s_nop 1
  v_add_f32_dpp v26, v26, v26 row_ror:8 row_mask:0xf bank_mask:0xf
  v_add_f32_dpp v27, v27, v27 row_ror:8 row_mask:0xf bank_mask:0xf
  s_nop 0
  v_add_f32_dpp v26, v26, v26 row_ror:4 row_mask:0xf bank_mask:0xf
  v_add_f32_dpp v27, v27, v27 row_ror:4 row_mask:0xf bank_mask:0xf
  s_nop 0
  v_add_f32_dpp v26, v26, v26 row_ror:2 row_mask:0xf bank_mask:0xf
  v_add_f32_dpp v27, v27, v27 row_ror:2 row_mask:0xf bank_mask:0xf
  s_nop 0
  v_add_f32_dpp v26, v26, v26 row_ror:1 row_mask:0xf bank_mask:0xf
  v_add_f32_dpp v27, v27, v27 row_ror:1 row_mask:0xf bank_mask:0xf
  s_nop 0
  v_lshlrev_b32 v28, 6, v3
  s_lshl_b32 s83, s74, 2
  v_add_u32 v28, s83, v28
  v_cmp_eq_u32 vcc, 0, v4
  s_and_saveexec_b64 s[96:97], vcc
  ds_write_b32 v28, v26 offset:5120
  ds_write_b32 v28, v27 offset:5152
  s_mov_b64 exec, s[96:97]
  v_lshlrev_b32 v26, 16, v50
  v_and_b32 v27, s80, v50
  v_lshlrev_b32 v28, 16, v51
  v_and_b32 v29, s80, v51
  v_lshlrev_b32 v30, 16, v52
  v_and_b32 v31, s80, v52
  v_lshlrev_b32 v58, 16, v53
  v_and_b32 v59, s80, v53
  v_mul_f32 v26, v26, v60
  v_mul_f32 v27, v27, v60
  v_mul_f32 v28, v28, v60
  v_mul_f32 v29, v29, v60
  v_mul_f32 v30, v30, v60
  v_mul_f32 v31, v31, v60
  v_mul_f32 v58, v58, v60
  v_mul_f32 v59, v59, v60
  s_nop 1
  v_permlane32_swap_b32 v26, v30
  v_permlane32_swap_b32 v27, v31
  v_permlane32_swap_b32 v28, v58
  v_permlane32_swap_b32 v29, v59
  s_nop 0
  v_add_f32 v26, v26, v30
  v_add_f32 v27, v27, v31
  v_add_f32 v28, v28, v58
  v_add_f32 v29, v29, v59
  s_nop 1
  v_permlane16_swap_b32 v26, v28
  v_permlane16_swap_b32 v27, v29
  s_nop 0
  v_add_f32 v26, v26, v28
  v_add_f32 v27, v27, v29
  s_nop 1
  v_add_f32_dpp v26, v26, v26 row_ror:8 row_mask:0xf bank_mask:0xf
  v_add_f32_dpp v27, v27, v27 row_ror:8 row_mask:0xf bank_mask:0xf
  s_nop 0
  v_add_f32_dpp v26, v26, v26 row_ror:4 row_mask:0xf bank_mask:0xf
  v_add_f32_dpp v27, v27, v27 row_ror:4 row_mask:0xf bank_mask:0xf
  s_nop 0
  v_add_f32_dpp v26, v26, v26 row_ror:2 row_mask:0xf bank_mask:0xf
  v_add_f32_dpp v27, v27, v27 row_ror:2 row_mask:0xf bank_mask:0xf
  s_nop 0
  v_add_f32_dpp v26, v26, v26 row_ror:1 row_mask:0xf bank_mask:0xf
  v_add_f32_dpp v27, v27, v27 row_ror:1 row_mask:0xf bank_mask:0xf
  s_nop 0
  v_lshlrev_b32 v28, 6, v3
  s_lshl_b32 s83, s74, 2
  v_add_u32 v28, s83, v28
  v_cmp_eq_u32 vcc, 0, v4
  s_and_saveexec_b64 s[96:97], vcc
  ds_write_b32 v28, v26 offset:5376
  ds_write_b32 v28, v27 offset:5408
  s_mov_b64 exec, s[96:97]
  s_waitcnt lgkmcnt(0)
  s_barrier
  buffer_load_dwordx4 v[192:195], v2, s[28:31], s75 offen offset:0 nt
  buffer_load_dwordx4 v[196:199], v2, s[28:31], s75 offen offset:1024 nt
  buffer_load_dwordx4 v[200:203], v2, s[28:31], s75 offen offset:2048 nt
  buffer_load_dwordx4 v[204:207], v2, s[28:31], s75 offen offset:3072 nt
  buffer_load_dwordx4 v[208:211], v2, s[32:35], s75 offen offset:0 nt
  buffer_load_dwordx4 v[212:215], v2, s[32:35], s75 offen offset:1024 nt
  buffer_load_dwordx4 v[216:219], v2, s[32:35], s75 offen offset:2048 nt
  buffer_load_dwordx4 v[220:223], v2, s[32:35], s75 offen offset:3072 nt
  s_add_u32 s75, s75, 32768
  s_add_u32 s85, s73, 7
  s_and_b32 s85, s85, 7
  s_lshl_b32 s85, s85, 14
  buffer_load_dwordx4 v[120:123], v7, s[40:43], s85 offen
  buffer_load_dwordx4 v[124:127], v7, s[40:43], s85 offen offset:1024
  s_waitcnt vmcnt(38)
  v_dot2_f32_bf16 v22, v224, v8, 0
  v_dot2_f32_bf16 v23, v228, v8, 0
  v_dot2_f32_bf16 v24, v232, v8, 0
  v_dot2_f32_bf16 v25, v236, v8, 0
  v_dot2_f32_bf16 v22, v225, v9, v22
  v_dot2_f32_bf16 v23, v229, v9, v23
  v_dot2_f32_bf16 v24, v233, v9, v24
  v_dot2_f32_bf16 v25, v237, v9, v25
  v_dot2_f32_bf16 v22, v226, v10, v22
  v_dot2_f32_bf16 v23, v230, v10, v23
  v_dot2_f32_bf16 v24, v234, v10, v24
  v_dot2_f32_bf16 v25, v238, v10, v25
  v_dot2_f32_bf16 v22, v227, v11, v22
  v_dot2_f32_bf16 v23, v231, v11, v23
  v_dot2_f32_bf16 v24, v235, v11, v24
  v_dot2_f32_bf16 v25, v239, v11, v25
  v_add_f32_dpp v22, v22, v22 row_ror:8 row_mask:0xf bank_mask:0xf
  v_add_f32_dpp v23, v23, v23 row_ror:8 row_mask:0xf bank_mask:0xf
  v_add_f32_dpp v24, v24, v24 row_ror:8 row_mask:0xf bank_mask:0xf
  v_add_f32_dpp v25, v25, v25 row_ror:8 row_mask:0xf bank_mask:0xf
  v_add_f32_dpp v22, v22, v22 row_ror:4 row_mask:0xf bank_mask:0xf
  v_add_f32_dpp v23, v23, v23 row_ror:4 row_mask:0xf bank_mask:0xf
  v_add_f32_dpp v24, v24, v24 row_ror:4 row_mask:0xf bank_mask:0xf
  v_add_f32_dpp v25, v25, v25 row_ror:4 row_mask:0xf bank_mask:0xf
  v_add_f32_dpp v22, v22, v22 row_ror:2 row_mask:0xf bank_mask:0xf
  v_add_f32_dpp v23, v23, v23 row_ror:2 row_mask:0xf bank_mask:0xf
  v_add_f32_dpp v24, v24, v24 row_ror:2 row_mask:0xf bank_mask:0xf
  v_add_f32_dpp v25, v25, v25 row_ror:2 row_mask:0xf bank_mask:0xf
  v_add_f32_dpp v22, v22, v22 row_ror:1 row_mask:0xf bank_mask:0xf
  v_add_f32_dpp v23, v23, v23 row_ror:1 row_mask:0xf bank_mask:0xf
  v_add_f32_dpp v24, v24, v24 row_ror:1 row_mask:0xf bank_mask:0xf
  v_add_f32_dpp v25, v25, v25 row_ror:1 row_mask:0xf bank_mask:0xf
  v_cvt_pk_bf16_f32 v40, v22, v23
  v_cvt_pk_bf16_f32 v41, v24, v25
  v_lshlrev_b32 v22, 16, v40
  v_and_b32 v23, s80, v40
  v_lshlrev_b32 v24, 16, v41
  v_and_b32 v25, s80, v41
  v_mul_f32 v22, s78, v22
  v_mul_f32 v23, s78, v23
  v_mul_f32 v24, s78, v24
  v_mul_f32 v25, s78, v25
  v_cvt_pk_bf16_f32 v40, v22, v23
  v_cvt_pk_bf16_f32 v41, v24, v25
  v_lshlrev_b32 v22, 16, v40
  v_and_b32 v23, s80, v40
  v_lshlrev_b32 v24, 16, v41
  v_and_b32 v25, s80, v41
  v_max3_f32 v42, v20, v22, v23
  v_max3_f32 v42, v42, v24, v25
  v_sub_f32 v44, v20, v42
  v_mul_f32 v43, s79, v42
  v_mul_f32 v44, s79, v44
  v_fma_f32 v32, v22, s79, -v43
  v_fma_f32 v33, v23, s79, -v43
  v_fma_f32 v34, v24, s79, -v43
  v_fma_f32 v35, v25, s79, -v43
  v_exp_f32 v44, v44
  v_exp_f32 v32, v32
  v_exp_f32 v33, v33
  v_exp_f32 v34, v34
  v_exp_f32 v35, v35
  v_mov_b32 v20, v42
  v_perm_b32 v224, v244, v240, s87
  v_perm_b32 v225, v244, v240, s88
  v_perm_b32 v226, v245, v241, s87
  v_perm_b32 v227, v245, v241, s88
  v_perm_b32 v228, v246, v242, s87
  v_perm_b32 v229, v246, v242, s88
  v_perm_b32 v230, v247, v243, s87
  v_perm_b32 v231, v247, v243, s88
  v_perm_b32 v232, v252, v248, s87
  v_perm_b32 v233, v252, v248, s88
  v_perm_b32 v234, v253, v249, s87
  v_perm_b32 v235, v253, v249, s88
  v_perm_b32 v236, v254, v250, s87
  v_perm_b32 v237, v254, v250, s88
  v_perm_b32 v238, v255, v251, s87
  v_perm_b32 v239, v255, v251, s88
  v_mul_f32 v21, v21, v44
  v_pk_mul_f32 v[12:13], v[12:13], v[44:45] op_sel_hi:[1,0]
  v_pk_mul_f32 v[14:15], v[14:15], v[44:45] op_sel_hi:[1,0]
  v_pk_mul_f32 v[16:17], v[16:17], v[44:45] op_sel_hi:[1,0]
  v_pk_mul_f32 v[18:19], v[18:19], v[44:45] op_sel_hi:[1,0]
  v_cvt_pk_bf16_f32 v36, v32, v33
  v_cvt_pk_bf16_f32 v37, v34, v35
  v_add_f32 v40, v32, v33
  v_add_f32 v41, v34, v35
  v_add_f32 v40, v40, v41
  v_add_f32 v21, v21, v40
  v_dot2_f32_bf16 v12, v224, v36, v12
  v_dot2_f32_bf16 v13, v225, v36, v13
  v_dot2_f32_bf16 v14, v226, v36, v14
  v_dot2_f32_bf16 v15, v227, v36, v15
  v_dot2_f32_bf16 v16, v228, v36, v16
  v_dot2_f32_bf16 v17, v229, v36, v17
  v_dot2_f32_bf16 v18, v230, v36, v18
  v_dot2_f32_bf16 v19, v231, v36, v19
  v_dot2_f32_bf16 v12, v232, v37, v12
  v_dot2_f32_bf16 v13, v233, v37, v13
  v_dot2_f32_bf16 v14, v234, v37, v14
  v_dot2_f32_bf16 v15, v235, v37, v15
  v_dot2_f32_bf16 v16, v236, v37, v16
  v_dot2_f32_bf16 v17, v237, v37, v17
  v_dot2_f32_bf16 v18, v238, v37, v18
  v_dot2_f32_bf16 v19, v239, v37, v19
  s_barrier
  buffer_load_dwordx4 v[224:227], v2, s[28:31], s75 offen offset:0 nt
  buffer_load_dwordx4 v[228:231], v2, s[28:31], s75 offen offset:1024 nt
  buffer_load_dwordx4 v[232:235], v2, s[28:31], s75 offen offset:2048 nt
  buffer_load_dwordx4 v[236:239], v2, s[28:31], s75 offen offset:3072 nt
  buffer_load_dwordx4 v[240:243], v2, s[32:35], s75 offen offset:0 nt
  buffer_load_dwordx4 v[244:247], v2, s[32:35], s75 offen offset:1024 nt
  buffer_load_dwordx4 v[248:251], v2, s[32:35], s75 offen offset:2048 nt
  buffer_load_dwordx4 v[252:255], v2, s[32:35], s75 offen offset:3072 nt
  s_add_u32 s75, s75, 32768
  v_lshrrev_b32 v62, 3, v1
  v_lshlrev_b32 v62, 5, v62
  ds_read_b128 v[46:49], v62 offset:5120
  ds_read_b128 v[50:53], v62 offset:5136
  ds_read_b128 v[26:29], v62 offset:5376
  ds_read_b64 v[30:31], v62 offset:5392
  ds_read_b64 v[58:59], v62 offset:5400
  s_waitcnt lgkmcnt(0)
  v_add_f32 v46, v46, v47
  v_add_f32 v26, v26, v27
  v_add_f32 v46, v46, v48
  v_add_f32 v26, v26, v28
  v_add_f32 v46, v46, v49
  v_add_f32 v26, v26, v29
  v_add_f32 v46, v46, v50
  v_add_f32 v26, v26, v30
  v_add_f32 v46, v46, v51
  v_add_f32 v26, v26, v31
  v_add_f32 v46, v46, v52
  v_add_f32 v26, v26, v58
  v_add_f32 v46, v46, v53
  v_add_f32 v26, v26, v59
  v_cvt_pk_bf16_f32 v63, v46, v26
  v_lshlrev_b32 v46, 16, v63
  v_and_b32 v26, s80, v63
  v_mul_f32 v47, s79, v46
  v_sub_f32 v47, 0, v47
  v_exp_f32 v47, v47
  s_nop 0
  v_add_f32 v47, 1.0, v47
  v_rcp_f32 v48, v47
  s_nop 0
  v_fma_f32 v49, -v47, v48, 1.0
  v_fma_f32 v48, v49, v48, v48
  v_cvt_pk_bf16_f32 v63, v48, v48
  v_lshlrev_b32 v48, 16, v63
  v_mul_f32 v48, v48, v26
  v_cvt_pk_bf16_f32 v63, v48, v48
  v_lshlrev_b32 v48, 16, v63
  v_lshlrev_b32 v26, 16, v54
  v_and_b32 v27, s80, v54
  v_lshlrev_b32 v28, 16, v55
  v_and_b32 v29, s80, v55
  v_lshlrev_b32 v30, 16, v56
  v_and_b32 v31, s80, v56
  v_lshlrev_b32 v58, 16, v57
  v_and_b32 v59, s80, v57
  v_mul_f32 v26, v26, v48
  v_mul_f32 v27, v27, v48
  v_mul_f32 v28, v28, v48
  v_mul_f32 v29, v29, v48
  v_mul_f32 v30, v30, v48
  v_mul_f32 v31, v31, v48
  v_mul_f32 v58, v58, v48
  v_mul_f32 v59, v59, v48
  s_nop 1
  v_add_f32_dpp v26, v26, v26 row_ror:8 row_mask:0xf bank_mask:0xf
  v_add_f32_dpp v27, v27, v27 row_ror:8 row_mask:0xf bank_mask:0xf
  v_add_f32_dpp v28, v28, v28 row_ror:8 row_mask:0xf bank_mask:0xf
  v_add_f32_dpp v29, v29, v29 row_ror:8 row_mask:0xf bank_mask:0xf
  v_add_f32_dpp v30, v30, v30 row_ror:8 row_mask:0xf bank_mask:0xf
  v_add_f32_dpp v31, v31, v31 row_ror:8 row_mask:0xf bank_mask:0xf
  v_add_f32_dpp v58, v58, v58 row_ror:8 row_mask:0xf bank_mask:0xf
  v_add_f32_dpp v59, v59, v59 row_ror:8 row_mask:0xf bank_mask:0xf
  s_nop 1
  v_permlane32_swap_b32 v26, v30
  v_permlane32_swap_b32 v27, v31
  v_permlane32_swap_b32 v28, v58
  v_permlane32_swap_b32 v29, v59
  s_nop 0
  v_add_f32 v26, v26, v30
  v_add_f32 v27, v27, v31
  v_add_f32 v28, v28, v58
  v_add_f32 v29, v29, v59
  s_nop 1
  v_permlane16_swap_b32 v26, v28
  v_permlane16_swap_b32 v27, v29
  s_nop 0
  v_add_f32 v26, v26, v28
  v_add_f32 v27, v27, v29
  v_and_b32 v62, 7, v1
  v_lshrrev_b32 v63, 2, v62
  v_lshlrev_b32 v63, 15, v63
  v_and_b32 v62, 3, v62
  v_lshl_add_u32 v63, v62, 5, v63
  v_and_b32 v62, 1, v3
  v_lshl_add_u32 v63, v62, 3, v63
  v_lshrrev_b32 v62, 1, v3
  v_lshl_add_u32 v63, v62, 4, v63
  s_lshl_b32 s83, s74, 16
  s_lshl_b32 s84, s82, 7
  s_add_u32 s83, s83, s84
  s_add_u32 s83, s83, 524288
  v_and_b32 v62, 8, v1
  v_cmp_eq_u32 vcc, 0, v62
  s_cmp_eq_u32 s86, 0
  s_cbranch_scc1 L_skip_glu
  s_and_saveexec_b64 s[96:97], vcc
  buffer_store_dwordx2 v[26:27], v63, s[60:63], s83 offen sc0 sc1
  s_mov_b64 exec, s[96:97]
L_skip_glu:
  s_waitcnt vmcnt(34)
  v_dot2_f32_bf16 v22, v128, v8, 0
  v_dot2_f32_bf16 v23, v132, v8, 0
  v_dot2_f32_bf16 v24, v136, v8, 0
  v_dot2_f32_bf16 v25, v140, v8, 0
  v_dot2_f32_bf16 v22, v129, v9, v22
  v_dot2_f32_bf16 v23, v133, v9, v23
  v_dot2_f32_bf16 v24, v137, v9, v24
  v_dot2_f32_bf16 v25, v141, v9, v25
  v_dot2_f32_bf16 v22, v130, v10, v22
  v_dot2_f32_bf16 v23, v134, v10, v23
  v_dot2_f32_bf16 v24, v138, v10, v24
  v_dot2_f32_bf16 v25, v142, v10, v25
  v_dot2_f32_bf16 v22, v131, v11, v22
  v_dot2_f32_bf16 v23, v135, v11, v23
  v_dot2_f32_bf16 v24, v139, v11, v24
  v_dot2_f32_bf16 v25, v143, v11, v25
  v_add_f32_dpp v22, v22, v22 row_ror:8 row_mask:0xf bank_mask:0xf
  v_add_f32_dpp v23, v23, v23 row_ror:8 row_mask:0xf bank_mask:0xf
  v_add_f32_dpp v24, v24, v24 row_ror:8 row_mask:0xf bank_mask:0xf
  v_add_f32_dpp v25, v25, v25 row_ror:8 row_mask:0xf bank_mask:0xf
  v_add_f32_dpp v22, v22, v22 row_ror:4 row_mask:0xf bank_mask:0xf
  v_add_f32_dpp v23, v23, v23 row_ror:4 row_mask:0xf bank_mask:0xf
  v_add_f32_dpp v24, v24, v24 row_ror:4 row_mask:0xf bank_mask:0xf
  v_add_f32_dpp v25, v25, v25 row_ror:4 row_mask:0xf bank_mask:0xf
  v_add_f32_dpp v22, v22, v22 row_ror:2 row_mask:0xf bank_mask:0xf
  v_add_f32_dpp v23, v23, v23 row_ror:2 row_mask:0xf bank_mask:0xf
  v_add_f32_dpp v24, v24, v24 row_ror:2 row_mask:0xf bank_mask:0xf
  v_add_f32_dpp v25, v25, v25 row_ror:2 row_mask:0xf bank_mask:0xf
  v_add_f32_dpp v22, v22, v22 row_ror:1 row_mask:0xf bank_mask:0xf
  v_add_f32_dpp v23, v23, v23 row_ror:1 row_mask:0xf bank_mask:0xf
  v_add_f32_dpp v24, v24, v24 row_ror:1 row_mask:0xf bank_mask:0xf
  v_add_f32_dpp v25, v25, v25 row_ror:1 row_mask:0xf bank_mask:0xf
  v_cvt_pk_bf16_f32 v40, v22, v23
  v_cvt_pk_bf16_f32 v41, v24, v25
  v_lshlrev_b32 v22, 16, v40
  v_and_b32 v23, s80, v40
  v_lshlrev_b32 v24, 16, v41
  v_and_b32 v25, s80, v41
  v_mul_f32 v22, s78, v22
  v_mul_f32 v23, s78, v23
  v_mul_f32 v24, s78, v24
  v_mul_f32 v25, s78, v25
  v_cvt_pk_bf16_f32 v40, v22, v23
  v_cvt_pk_bf16_f32 v41, v24, v25
  v_lshlrev_b32 v22, 16, v40
  v_and_b32 v23, s80, v40
  v_lshlrev_b32 v24, 16, v41
  v_and_b32 v25, s80, v41
  v_max3_f32 v42, v20, v22, v23
  v_max3_f32 v42, v42, v24, v25
  v_sub_f32 v44, v20, v42
  v_mul_f32 v43, s79, v42
  v_mul_f32 v44, s79, v44
  v_fma_f32 v32, v22, s79, -v43
  v_fma_f32 v33, v23, s79, -v43
  v_fma_f32 v34, v24, s79, -v43
  v_fma_f32 v35, v25, s79, -v43
  v_exp_f32 v44, v44
  v_exp_f32 v32, v32
  v_exp_f32 v33, v33
  v_exp_f32 v34, v34
  v_exp_f32 v35, v35
  v_mov_b32 v20, v42
  v_perm_b32 v128, v148, v144, s87
  v_perm_b32 v129, v148, v144, s88
  v_perm_b32 v130, v149, v145, s87
  v_perm_b32 v131, v149, v145, s88
  v_perm_b32 v132, v150, v146, s87
  v_perm_b32 v133, v150, v146, s88
  v_perm_b32 v134, v151, v147, s87
  v_perm_b32 v135, v151, v147, s88
  v_perm_b32 v136, v156, v152, s87
  v_perm_b32 v137, v156, v152, s88
  v_perm_b32 v138, v157, v153, s87
  v_perm_b32 v139, v157, v153, s88
  v_perm_b32 v140, v158, v154, s87
  v_perm_b32 v141, v158, v154, s88
  v_perm_b32 v142, v159, v155, s87
  v_perm_b32 v143, v159, v155, s88
  v_mul_f32 v21, v21, v44
  v_pk_mul_f32 v[12:13], v[12:13], v[44:45] op_sel_hi:[1,0]
  v_pk_mul_f32 v[14:15], v[14:15], v[44:45] op_sel_hi:[1,0]
  v_pk_mul_f32 v[16:17], v[16:17], v[44:45] op_sel_hi:[1,0]
  v_pk_mul_f32 v[18:19], v[18:19], v[44:45] op_sel_hi:[1,0]
  v_cvt_pk_bf16_f32 v36, v32, v33
  v_cvt_pk_bf16_f32 v37, v34, v35
  v_add_f32 v40, v32, v33
  v_add_f32 v41, v34, v35
  v_add_f32 v40, v40, v41
  v_add_f32 v21, v21, v40
  v_dot2_f32_bf16 v12, v128, v36, v12
  v_dot2_f32_bf16 v13, v129, v36, v13
  v_dot2_f32_bf16 v14, v130, v36, v14
  v_dot2_f32_bf16 v15, v131, v36, v15
  v_dot2_f32_bf16 v16, v132, v36, v16
  v_dot2_f32_bf16 v17, v133, v36, v17
  v_dot2_f32_bf16 v18, v134, v36, v18
  v_dot2_f32_bf16 v19, v135, v36, v19
  v_dot2_f32_bf16 v12, v136, v37, v12
  v_dot2_f32_bf16 v13, v137, v37, v13
  v_dot2_f32_bf16 v14, v138, v37, v14
  v_dot2_f32_bf16 v15, v139, v37, v15
  v_dot2_f32_bf16 v16, v140, v37, v16
  v_dot2_f32_bf16 v17, v141, v37, v17
  v_dot2_f32_bf16 v18, v142, v37, v18
  v_dot2_f32_bf16 v19, v143, v37, v19
  s_barrier
  buffer_load_dwordx4 v[128:131], v2, s[28:31], s75 offen offset:0 nt
  buffer_load_dwordx4 v[132:135], v2, s[28:31], s75 offen offset:1024 nt
  buffer_load_dwordx4 v[136:139], v2, s[28:31], s75 offen offset:2048 nt
  buffer_load_dwordx4 v[140:143], v2, s[28:31], s75 offen offset:3072 nt
  buffer_load_dwordx4 v[144:147], v2, s[32:35], s75 offen offset:0 nt
  buffer_load_dwordx4 v[148:151], v2, s[32:35], s75 offen offset:1024 nt
  buffer_load_dwordx4 v[152:155], v2, s[32:35], s75 offen offset:2048 nt
  buffer_load_dwordx4 v[156:159], v2, s[32:35], s75 offen offset:3072 nt
  s_add_u32 s75, s75, 32768
  s_waitcnt vmcnt(30)
  v_dot2_f32_bf16 v22, v160, v8, 0
  v_dot2_f32_bf16 v23, v164, v8, 0
  v_dot2_f32_bf16 v24, v168, v8, 0
  v_dot2_f32_bf16 v25, v172, v8, 0
  v_dot2_f32_bf16 v22, v161, v9, v22
  v_dot2_f32_bf16 v23, v165, v9, v23
  v_dot2_f32_bf16 v24, v169, v9, v24
  v_dot2_f32_bf16 v25, v173, v9, v25
  v_dot2_f32_bf16 v22, v162, v10, v22
  v_dot2_f32_bf16 v23, v166, v10, v23
  v_dot2_f32_bf16 v24, v170, v10, v24
  v_dot2_f32_bf16 v25, v174, v10, v25
  v_dot2_f32_bf16 v22, v163, v11, v22
  v_dot2_f32_bf16 v23, v167, v11, v23
  v_dot2_f32_bf16 v24, v171, v11, v24
  v_dot2_f32_bf16 v25, v175, v11, v25
  v_add_f32_dpp v22, v22, v22 row_ror:8 row_mask:0xf bank_mask:0xf
  v_add_f32_dpp v23, v23, v23 row_ror:8 row_mask:0xf bank_mask:0xf
  v_add_f32_dpp v24, v24, v24 row_ror:8 row_mask:0xf bank_mask:0xf
  v_add_f32_dpp v25, v25, v25 row_ror:8 row_mask:0xf bank_mask:0xf
  v_add_f32_dpp v22, v22, v22 row_ror:4 row_mask:0xf bank_mask:0xf
  v_add_f32_dpp v23, v23, v23 row_ror:4 row_mask:0xf bank_mask:0xf
  v_add_f32_dpp v24, v24, v24 row_ror:4 row_mask:0xf bank_mask:0xf
  v_add_f32_dpp v25, v25, v25 row_ror:4 row_mask:0xf bank_mask:0xf
  v_add_f32_dpp v22, v22, v22 row_ror:2 row_mask:0xf bank_mask:0xf
  v_add_f32_dpp v23, v23, v23 row_ror:2 row_mask:0xf bank_mask:0xf
  v_add_f32_dpp v24, v24, v24 row_ror:2 row_mask:0xf bank_mask:0xf
  v_add_f32_dpp v25, v25, v25 row_ror:2 row_mask:0xf bank_mask:0xf
  v_add_f32_dpp v22, v22, v22 row_ror:1 row_mask:0xf bank_mask:0xf
  v_add_f32_dpp v23, v23, v23 row_ror:1 row_mask:0xf bank_mask:0xf
  v_add_f32_dpp v24, v24, v24 row_ror:1 row_mask:0xf bank_mask:0xf
  v_add_f32_dpp v25, v25, v25 row_ror:1 row_mask:0xf bank_mask:0xf
  v_cvt_pk_bf16_f32 v40, v22, v23
  v_cvt_pk_bf16_f32 v41, v24, v25
  v_lshlrev_b32 v22, 16, v40
  v_and_b32 v23, s80, v40
  v_lshlrev_b32 v24, 16, v41
  v_and_b32 v25, s80, v41
  v_mul_f32 v22, s78, v22
  v_mul_f32 v23, s78, v23
  v_mul_f32 v24, s78, v24
  v_mul_f32 v25, s78, v25
  v_cvt_pk_bf16_f32 v40, v22, v23
  v_cvt_pk_bf16_f32 v41, v24, v25
  v_lshlrev_b32 v22, 16, v40
  v_and_b32 v23, s80, v40
  v_lshlrev_b32 v24, 16, v41
  v_and_b32 v25, s80, v41
  v_max3_f32 v42, v20, v22, v23
  v_max3_f32 v42, v42, v24, v25
  v_sub_f32 v44, v20, v42
  v_mul_f32 v43, s79, v42
  v_mul_f32 v44, s79, v44
  v_fma_f32 v32, v22, s79, -v43
  v_fma_f32 v33, v23, s79, -v43
  v_fma_f32 v34, v24, s79, -v43
  v_fma_f32 v35, v25, s79, -v43
  v_exp_f32 v44, v44
  v_exp_f32 v32, v32
  v_exp_f32 v33, v33
  v_exp_f32 v34, v34
  v_exp_f32 v35, v35
  v_mov_b32 v20, v42
  v_perm_b32 v160, v180, v176, s87
  v_perm_b32 v161, v180, v176, s88
  v_perm_b32 v162, v181, v177, s87
  v_perm_b32 v163, v181, v177, s88
  v_perm_b32 v164, v182, v178, s87
  v_perm_b32 v165, v182, v178, s88
  v_perm_b32 v166, v183, v179, s87
  v_perm_b32 v167, v183, v179, s88
  v_perm_b32 v168, v188, v184, s87
  v_perm_b32 v169, v188, v184, s88
  v_perm_b32 v170, v189, v185, s87
  v_perm_b32 v171, v189, v185, s88
  v_perm_b32 v172, v190, v186, s87
  v_perm_b32 v173, v190, v186, s88
  v_perm_b32 v174, v191, v187, s87
  v_perm_b32 v175, v191, v187, s88
  v_mul_f32 v21, v21, v44
  v_pk_mul_f32 v[12:13], v[12:13], v[44:45] op_sel_hi:[1,0]
  v_pk_mul_f32 v[14:15], v[14:15], v[44:45] op_sel_hi:[1,0]
  v_pk_mul_f32 v[16:17], v[16:17], v[44:45] op_sel_hi:[1,0]
  v_pk_mul_f32 v[18:19], v[18:19], v[44:45] op_sel_hi:[1,0]
  v_cvt_pk_bf16_f32 v36, v32, v33
  v_cvt_pk_bf16_f32 v37, v34, v35
  v_add_f32 v40, v32, v33
  v_add_f32 v41, v34, v35
  v_add_f32 v40, v40, v41
  v_add_f32 v21, v21, v40
  v_dot2_f32_bf16 v12, v160, v36, v12
  v_dot2_f32_bf16 v13, v161, v36, v13
  v_dot2_f32_bf16 v14, v162, v36, v14
  v_dot2_f32_bf16 v15, v163, v36, v15
  v_dot2_f32_bf16 v16, v164, v36, v16
  v_dot2_f32_bf16 v17, v165, v36, v17
  v_dot2_f32_bf16 v18, v166, v36, v18
  v_dot2_f32_bf16 v19, v167, v36, v19
  v_dot2_f32_bf16 v12, v168, v37, v12
  v_dot2_f32_bf16 v13, v169, v37, v13
  v_dot2_f32_bf16 v14, v170, v37, v14
  v_dot2_f32_bf16 v15, v171, v37, v15
  v_dot2_f32_bf16 v16, v172, v37, v16
  v_dot2_f32_bf16 v17, v173, v37, v17
  v_dot2_f32_bf16 v18, v174, v37, v18
  v_dot2_f32_bf16 v19, v175, v37, v19
  s_barrier
  buffer_load_dwordx4 v[160:163], v2, s[28:31], s75 offen offset:0 nt
  buffer_load_dwordx4 v[164:167], v2, s[28:31], s75 offen offset:1024 nt
  buffer_load_dwordx4 v[168:171], v2, s[28:31], s75 offen offset:2048 nt
  buffer_load_dwordx4 v[172:175], v2, s[28:31], s75 offen offset:3072 nt
  buffer_load_dwordx4 v[176:179], v2, s[32:35], s75 offen offset:0 nt
  buffer_load_dwordx4 v[180:183], v2, s[32:35], s75 offen offset:1024 nt
  buffer_load_dwordx4 v[184:187], v2, s[32:35], s75 offen offset:2048 nt
  buffer_load_dwordx4 v[188:191], v2, s[32:35], s75 offen offset:3072 nt
  s_add_u32 s75, s75, 32768
  s_waitcnt vmcnt(26)
  v_dot2_f32_bf16 v22, v192, v8, 0
  v_dot2_f32_bf16 v23, v196, v8, 0
  v_dot2_f32_bf16 v24, v200, v8, 0
  v_dot2_f32_bf16 v25, v204, v8, 0
  v_dot2_f32_bf16 v22, v193, v9, v22
  v_dot2_f32_bf16 v23, v197, v9, v23
  v_dot2_f32_bf16 v24, v201, v9, v24
  v_dot2_f32_bf16 v25, v205, v9, v25
  v_dot2_f32_bf16 v22, v194, v10, v22
  v_dot2_f32_bf16 v23, v198, v10, v23
  v_dot2_f32_bf16 v24, v202, v10, v24
  v_dot2_f32_bf16 v25, v206, v10, v25
  v_dot2_f32_bf16 v22, v195, v11, v22
  v_dot2_f32_bf16 v23, v199, v11, v23
  v_dot2_f32_bf16 v24, v203, v11, v24
  v_dot2_f32_bf16 v25, v207, v11, v25
  v_add_f32_dpp v22, v22, v22 row_ror:8 row_mask:0xf bank_mask:0xf
  v_add_f32_dpp v23, v23, v23 row_ror:8 row_mask:0xf bank_mask:0xf
  v_add_f32_dpp v24, v24, v24 row_ror:8 row_mask:0xf bank_mask:0xf
  v_add_f32_dpp v25, v25, v25 row_ror:8 row_mask:0xf bank_mask:0xf
  v_add_f32_dpp v22, v22, v22 row_ror:4 row_mask:0xf bank_mask:0xf
  v_add_f32_dpp v23, v23, v23 row_ror:4 row_mask:0xf bank_mask:0xf
  v_add_f32_dpp v24, v24, v24 row_ror:4 row_mask:0xf bank_mask:0xf
  v_add_f32_dpp v25, v25, v25 row_ror:4 row_mask:0xf bank_mask:0xf
  v_add_f32_dpp v22, v22, v22 row_ror:2 row_mask:0xf bank_mask:0xf
  v_add_f32_dpp v23, v23, v23 row_ror:2 row_mask:0xf bank_mask:0xf
  v_add_f32_dpp v24, v24, v24 row_ror:2 row_mask:0xf bank_mask:0xf
  v_add_f32_dpp v25, v25, v25 row_ror:2 row_mask:0xf bank_mask:0xf
  v_add_f32_dpp v22, v22, v22 row_ror:1 row_mask:0xf bank_mask:0xf
  v_add_f32_dpp v23, v23, v23 row_ror:1 row_mask:0xf bank_mask:0xf
  v_add_f32_dpp v24, v24, v24 row_ror:1 row_mask:0xf bank_mask:0xf
  v_add_f32_dpp v25, v25, v25 row_ror:1 row_mask:0xf bank_mask:0xf
  v_cvt_pk_bf16_f32 v40, v22, v23
  v_cvt_pk_bf16_f32 v41, v24, v25
  v_lshlrev_b32 v22, 16, v40
  v_and_b32 v23, s80, v40
  v_lshlrev_b32 v24, 16, v41
  v_and_b32 v25, s80, v41
  v_mul_f32 v22, s78, v22
  v_mul_f32 v23, s78, v23
  v_mul_f32 v24, s78, v24
  v_mul_f32 v25, s78, v25
  v_cvt_pk_bf16_f32 v40, v22, v23
  v_cvt_pk_bf16_f32 v41, v24, v25
  v_lshlrev_b32 v22, 16, v40
  v_and_b32 v23, s80, v40
  v_lshlrev_b32 v24, 16, v41
  v_and_b32 v25, s80, v41
  v_max3_f32 v42, v20, v22, v23
  v_max3_f32 v42, v42, v24, v25
  v_sub_f32 v44, v20, v42
  v_mul_f32 v43, s79, v42
  v_mul_f32 v44, s79, v44
  v_fma_f32 v32, v22, s79, -v43
  v_fma_f32 v33, v23, s79, -v43
  v_fma_f32 v34, v24, s79, -v43
  v_fma_f32 v35, v25, s79, -v43
  v_exp_f32 v44, v44
  v_exp_f32 v32, v32
  v_exp_f32 v33, v33
  v_exp_f32 v34, v34
  v_exp_f32 v35, v35
  v_mov_b32 v20, v42
  v_perm_b32 v192, v212, v208, s87
  v_perm_b32 v193, v212, v208, s88
  v_perm_b32 v194, v213, v209, s87
  v_perm_b32 v195, v213, v209, s88
  v_perm_b32 v196, v214, v210, s87
  v_perm_b32 v197, v214, v210, s88
  v_perm_b32 v198, v215, v211, s87
  v_perm_b32 v199, v215, v211, s88
  v_perm_b32 v200, v220, v216, s87
  v_perm_b32 v201, v220, v216, s88
  v_perm_b32 v202, v221, v217, s87
  v_perm_b32 v203, v221, v217, s88
  v_perm_b32 v204, v222, v218, s87
  v_perm_b32 v205, v222, v218, s88
  v_perm_b32 v206, v223, v219, s87
  v_perm_b32 v207, v223, v219, s88
  v_mul_f32 v21, v21, v44
  v_pk_mul_f32 v[12:13], v[12:13], v[44:45] op_sel_hi:[1,0]
  v_pk_mul_f32 v[14:15], v[14:15], v[44:45] op_sel_hi:[1,0]
  v_pk_mul_f32 v[16:17], v[16:17], v[44:45] op_sel_hi:[1,0]
  v_pk_mul_f32 v[18:19], v[18:19], v[44:45] op_sel_hi:[1,0]
  v_cvt_pk_bf16_f32 v36, v32, v33
  v_cvt_pk_bf16_f32 v37, v34, v35
  v_add_f32 v40, v32, v33
  v_add_f32 v41, v34, v35
  v_add_f32 v40, v40, v41
  v_add_f32 v21, v21, v40
  v_dot2_f32_bf16 v12, v192, v36, v12
  v_dot2_f32_bf16 v13, v193, v36, v13
  v_dot2_f32_bf16 v14, v194, v36, v14
  v_dot2_f32_bf16 v15, v195, v36, v15
  v_dot2_f32_bf16 v16, v196, v36, v16
  v_dot2_f32_bf16 v17, v197, v36, v17
  v_dot2_f32_bf16 v18, v198, v36, v18
  v_dot2_f32_bf16 v19, v199, v36, v19
  v_dot2_f32_bf16 v12, v200, v37, v12
  v_dot2_f32_bf16 v13, v201, v37, v13
  v_dot2_f32_bf16 v14, v202, v37, v14
  v_dot2_f32_bf16 v15, v203, v37, v15
  v_dot2_f32_bf16 v16, v204, v37, v16
  v_dot2_f32_bf16 v17, v205, v37, v17
  v_dot2_f32_bf16 v18, v206, v37, v18
  v_dot2_f32_bf16 v19, v207, v37, v19
  s_barrier
  buffer_load_dwordx4 v[192:195], v2, s[28:31], s75 offen offset:0 nt
  buffer_load_dwordx4 v[196:199], v2, s[28:31], s75 offen offset:1024 nt
  buffer_load_dwordx4 v[200:203], v2, s[28:31], s75 offen offset:2048 nt
  buffer_load_dwordx4 v[204:207], v2, s[28:31], s75 offen offset:3072 nt
  buffer_load_dwordx4 v[208:211], v2, s[32:35], s75 offen offset:0 nt
  buffer_load_dwordx4 v[212:215], v2, s[32:35], s75 offen offset:1024 nt
  buffer_load_dwordx4 v[216:219], v2, s[32:35], s75 offen offset:2048 nt
  buffer_load_dwordx4 v[220:223], v2, s[32:35], s75 offen offset:3072 nt
  s_add_u32 s75, s75, 32768
  s_waitcnt vmcnt(24)
  v_dot2_f32_bf16 v22, v224, v8, 0
  v_dot2_f32_bf16 v23, v228, v8, 0
  v_dot2_f32_bf16 v24, v232, v8, 0
  v_dot2_f32_bf16 v25, v236, v8, 0
  v_dot2_f32_bf16 v22, v225, v9, v22
  v_dot2_f32_bf16 v23, v229, v9, v23
  v_dot2_f32_bf16 v24, v233, v9, v24
  v_dot2_f32_bf16 v25, v237, v9, v25
  v_dot2_f32_bf16 v22, v226, v10, v22
  v_dot2_f32_bf16 v23, v230, v10, v23
  v_dot2_f32_bf16 v24, v234, v10, v24
  v_dot2_f32_bf16 v25, v238, v10, v25
  v_dot2_f32_bf16 v22, v227, v11, v22
  v_dot2_f32_bf16 v23, v231, v11, v23
  v_dot2_f32_bf16 v24, v235, v11, v24
  v_dot2_f32_bf16 v25, v239, v11, v25
  v_add_f32_dpp v22, v22, v22 row_ror:8 row_mask:0xf bank_mask:0xf
  v_add_f32_dpp v23, v23, v23 row_ror:8 row_mask:0xf bank_mask:0xf
  v_add_f32_dpp v24, v24, v24 row_ror:8 row_mask:0xf bank_mask:0xf
  v_add_f32_dpp v25, v25, v25 row_ror:8 row_mask:0xf bank_mask:0xf
  v_add_f32_dpp v22, v22, v22 row_ror:4 row_mask:0xf bank_mask:0xf
  v_add_f32_dpp v23, v23, v23 row_ror:4 row_mask:0xf bank_mask:0xf
  v_add_f32_dpp v24, v24, v24 row_ror:4 row_mask:0xf bank_mask:0xf
  v_add_f32_dpp v25, v25, v25 row_ror:4 row_mask:0xf bank_mask:0xf
  v_add_f32_dpp v22, v22, v22 row_ror:2 row_mask:0xf bank_mask:0xf
  v_add_f32_dpp v23, v23, v23 row_ror:2 row_mask:0xf bank_mask:0xf
  v_add_f32_dpp v24, v24, v24 row_ror:2 row_mask:0xf bank_mask:0xf
  v_add_f32_dpp v25, v25, v25 row_ror:2 row_mask:0xf bank_mask:0xf
  v_add_f32_dpp v22, v22, v22 row_ror:1 row_mask:0xf bank_mask:0xf
  v_add_f32_dpp v23, v23, v23 row_ror:1 row_mask:0xf bank_mask:0xf
  v_add_f32_dpp v24, v24, v24 row_ror:1 row_mask:0xf bank_mask:0xf
  v_add_f32_dpp v25, v25, v25 row_ror:1 row_mask:0xf bank_mask:0xf
  v_cvt_pk_bf16_f32 v40, v22, v23
  v_cvt_pk_bf16_f32 v41, v24, v25
  v_lshlrev_b32 v22, 16, v40
  v_and_b32 v23, s80, v40
  v_lshlrev_b32 v24, 16, v41
  v_and_b32 v25, s80, v41
  v_mul_f32 v22, s78, v22
  v_mul_f32 v23, s78, v23
  v_mul_f32 v24, s78, v24
  v_mul_f32 v25, s78, v25
  v_cvt_pk_bf16_f32 v40, v22, v23
  v_cvt_pk_bf16_f32 v41, v24, v25
  v_lshlrev_b32 v22, 16, v40
  v_and_b32 v23, s80, v40
  v_lshlrev_b32 v24, 16, v41
  v_and_b32 v25, s80, v41
  v_max3_f32 v42, v20, v22, v23
  v_max3_f32 v42, v42, v24, v25
  v_sub_f32 v44, v20, v42
  v_mul_f32 v43, s79, v42
  v_mul_f32 v44, s79, v44
  v_fma_f32 v32, v22, s79, -v43
  v_fma_f32 v33, v23, s79, -v43
  v_fma_f32 v34, v24, s79, -v43
  v_fma_f32 v35, v25, s79, -v43
  v_exp_f32 v44, v44
  v_exp_f32 v32, v32
  v_exp_f32 v33, v33
  v_exp_f32 v34, v34
  v_exp_f32 v35, v35
  v_mov_b32 v20, v42
  v_perm_b32 v224, v244, v240, s87
  v_perm_b32 v225, v244, v240, s88
  v_perm_b32 v226, v245, v241, s87
  v_perm_b32 v227, v245, v241, s88
  v_perm_b32 v228, v246, v242, s87
  v_perm_b32 v229, v246, v242, s88
  v_perm_b32 v230, v247, v243, s87
  v_perm_b32 v231, v247, v243, s88
  v_perm_b32 v232, v252, v248, s87
  v_perm_b32 v233, v252, v248, s88
  v_perm_b32 v234, v253, v249, s87
  v_perm_b32 v235, v253, v249, s88
  v_perm_b32 v236, v254, v250, s87
  v_perm_b32 v237, v254, v250, s88
  v_perm_b32 v238, v255, v251, s87
  v_perm_b32 v239, v255, v251, s88
  v_mul_f32 v21, v21, v44
  v_pk_mul_f32 v[12:13], v[12:13], v[44:45] op_sel_hi:[1,0]
  v_pk_mul_f32 v[14:15], v[14:15], v[44:45] op_sel_hi:[1,0]
  v_pk_mul_f32 v[16:17], v[16:17], v[44:45] op_sel_hi:[1,0]
  v_pk_mul_f32 v[18:19], v[18:19], v[44:45] op_sel_hi:[1,0]
  v_cvt_pk_bf16_f32 v36, v32, v33
  v_cvt_pk_bf16_f32 v37, v34, v35
  v_add_f32 v40, v32, v33
  v_add_f32 v41, v34, v35
  v_add_f32 v40, v40, v41
  v_add_f32 v21, v21, v40
  v_dot2_f32_bf16 v12, v224, v36, v12
  v_dot2_f32_bf16 v13, v225, v36, v13
  v_dot2_f32_bf16 v14, v226, v36, v14
  v_dot2_f32_bf16 v15, v227, v36, v15
  v_dot2_f32_bf16 v16, v228, v36, v16
  v_dot2_f32_bf16 v17, v229, v36, v17
  v_dot2_f32_bf16 v18, v230, v36, v18
  v_dot2_f32_bf16 v19, v231, v36, v19
  v_dot2_f32_bf16 v12, v232, v37, v12
  v_dot2_f32_bf16 v13, v233, v37, v13
  v_dot2_f32_bf16 v14, v234, v37, v14
  v_dot2_f32_bf16 v15, v235, v37, v15
  v_dot2_f32_bf16 v16, v236, v37, v16
  v_dot2_f32_bf16 v17, v237, v37, v17
  v_dot2_f32_bf16 v18, v238, v37, v18
  v_dot2_f32_bf16 v19, v239, v37, v19
  s_barrier
  buffer_load_dwordx4 v[224:227], v2, s[28:31], s75 offen offset:0 nt
  buffer_load_dwordx4 v[228:231], v2, s[28:31], s75 offen offset:1024 nt
  buffer_load_dwordx4 v[232:235], v2, s[28:31], s75 offen offset:2048 nt
  buffer_load_dwordx4 v[236:239], v2, s[28:31], s75 offen offset:3072 nt
  buffer_load_dwordx4 v[240:243], v2, s[32:35], s75 offen offset:0 nt
  buffer_load_dwordx4 v[244:247], v2, s[32:35], s75 offen offset:1024 nt
  buffer_load_dwordx4 v[248:251], v2, s[32:35], s75 offen offset:2048 nt
  buffer_load_dwordx4 v[252:255], v2, s[32:35], s75 offen offset:3072 nt
  s_add_u32 s75, s75, 32768
  v_perm_b32 v40, v68, v64, s87
  v_perm_b32 v68, v68, v64, s88
  v_mov_b32 v64, v40
  v_perm_b32 v41, v69, v65, s87
  v_perm_b32 v69, v69, v65, s88
  v_mov_b32 v65, v41
  v_perm_b32 v40, v70, v66, s87
  v_perm_b32 v70, v70, v66, s88
  v_mov_b32 v66, v40
  v_perm_b32 v41, v71, v67, s87
  v_perm_b32 v71, v71, v67, s88
  v_mov_b32 v67, v41
  v_perm_b32 v40, v76, v72, s87
  v_perm_b32 v76, v76, v72, s88
  v_mov_b32 v72, v40
  v_perm_b32 v41, v77, v73, s87
  v_perm_b32 v77, v77, v73, s88
  v_mov_b32 v73, v41
  v_perm_b32 v40, v78, v74, s87
  v_perm_b32 v78, v78, v74, s88
  v_mov_b32 v74, v40
  v_perm_b32 v41, v79, v75, s87
  v_perm_b32 v79, v79, v75, s88
  v_mov_b32 v75, v41
  v_perm_b32 v40, v84, v80, s87
  v_perm_b32 v84, v84, v80, s88
  v_mov_b32 v80, v40
  v_perm_b32 v41, v85, v81, s87
  v_perm_b32 v85, v85, v81, s88
  v_mov_b32 v81, v41
  v_perm_b32 v40, v86, v82, s87
  v_perm_b32 v86, v86, v82, s88
  v_mov_b32 v82, v40
  v_perm_b32 v41, v87, v83, s87
  v_perm_b32 v87, v87, v83, s88
  v_mov_b32 v83, v41
  v_perm_b32 v40, v92, v88, s87
  v_perm_b32 v92, v92, v88, s88
  v_mov_b32 v88, v40
  v_perm_b32 v41, v93, v89, s87
  v_perm_b32 v93, v93, v89, s88
  v_mov_b32 v89, v41
  v_perm_b32 v40, v94, v90, s87
  v_perm_b32 v94, v94, v90, s88
  v_mov_b32 v90, v40
  v_perm_b32 v41, v95, v91, s87
  v_perm_b32 v95, v95, v91, s88
  v_mov_b32 v91, v41
  v_perm_b32 v40, v100, v96, s87
  v_perm_b32 v100, v100, v96, s88
  v_mov_b32 v96, v40
  v_perm_b32 v41, v101, v97, s87
  v_perm_b32 v101, v101, v97, s88
  v_mov_b32 v97, v41
  v_perm_b32 v40, v102, v98, s87
  v_perm_b32 v102, v102, v98, s88
  v_mov_b32 v98, v40
  v_perm_b32 v41, v103, v99, s87
  v_perm_b32 v103, v103, v99, s88
  v_mov_b32 v99, v41
  v_perm_b32 v40, v108, v104, s87
  v_perm_b32 v108, v108, v104, s88
  v_mov_b32 v104, v40
  v_perm_b32 v41, v109, v105, s87
  v_perm_b32 v109, v109, v105, s88
  v_mov_b32 v105, v41
  v_perm_b32 v40, v110, v106, s87
  v_perm_b32 v110, v110, v106, s88
  v_mov_b32 v106, v40
  v_perm_b32 v41, v111, v107, s87
  v_perm_b32 v111, v111, v107, s88
  v_mov_b32 v107, v41
  v_perm_b32 v40, v116, v112, s87
  v_perm_b32 v116, v116, v112, s88
  v_mov_b32 v112, v40
  v_perm_b32 v41, v117, v113, s87
  v_perm_b32 v117, v117, v113, s88
  v_mov_b32 v113, v41
  v_perm_b32 v40, v118, v114, s87
  v_perm_b32 v118, v118, v114, s88
  v_mov_b32 v114, v40
  v_perm_b32 v41, v119, v115, s87
  v_perm_b32 v119, v119, v115, s88
  v_mov_b32 v115, v41
  v_perm_b32 v40, v124, v120, s87
  v_perm_b32 v124, v124, v120, s88
  v_mov_b32 v120, v40
  v_perm_b32 v41, v125, v121, s87
  v_perm_b32 v125, v125, v121, s88
  v_mov_b32 v121, v41
  v_perm_b32 v40, v126, v122, s87
  v_perm_b32 v126, v126, v122, s88
  v_mov_b32 v122, v40
  v_perm_b32 v41, v127, v123, s87
  v_perm_b32 v127, v127, v123, s88
  v_mov_b32 v123, v41
  s_mov_b32 s76, 4
L_loop:
  s_waitcnt vmcnt(24)
  v_dot2_f32_bf16 v22, v128, v8, 0
  v_dot2_f32_bf16 v23, v132, v8, 0
  v_dot2_f32_bf16 v24, v136, v8, 0
  v_dot2_f32_bf16 v25, v140, v8, 0
  v_dot2_f32_bf16 v22, v129, v9, v22
  v_dot2_f32_bf16 v23, v133, v9, v23
  v_dot2_f32_bf16 v24, v137, v9, v24
  v_dot2_f32_bf16 v25, v141, v9, v25
  v_dot2_f32_bf16 v22, v130, v10, v22
  v_dot2_f32_bf16 v23, v134, v10, v23
  v_dot2_f32_bf16 v24, v138, v10, v24
  v_dot2_f32_bf16 v25, v142, v10, v25
  v_dot2_f32_bf16 v22, v131, v11, v22
  v_dot2_f32_bf16 v23, v135, v11, v23
  v_dot2_f32_bf16 v24, v139, v11, v24
  v_dot2_f32_bf16 v25, v143, v11, v25
  v_add_f32_dpp v22, v22, v22 row_ror:8 row_mask:0xf bank_mask:0xf
  v_add_f32_dpp v23, v23, v23 row_ror:8 row_mask:0xf bank_mask:0xf
  v_add_f32_dpp v24, v24, v24 row_ror:8 row_mask:0xf bank_mask:0xf
  v_add_f32_dpp v25, v25, v25 row_ror:8 row_mask:0xf bank_mask:0xf
  v_add_f32_dpp v22, v22, v22 row_ror:4 row_mask:0xf bank_mask:0xf
  v_add_f32_dpp v23, v23, v23 row_ror:4 row_mask:0xf bank_mask:0xf
  v_add_f32_dpp v24, v24, v24 row_ror:4 row_mask:0xf bank_mask:0xf
  v_add_f32_dpp v25, v25, v25 row_ror:4 row_mask:0xf bank_mask:0xf
  v_add_f32_dpp v22, v22, v22 row_ror:2 row_mask:0xf bank_mask:0xf
  v_add_f32_dpp v23, v23, v23 row_ror:2 row_mask:0xf bank_mask:0xf
  v_add_f32_dpp v24, v24, v24 row_ror:2 row_mask:0xf bank_mask:0xf
  v_add_f32_dpp v25, v25, v25 row_ror:2 row_mask:0xf bank_mask:0xf
  v_add_f32_dpp v22, v22, v22 row_ror:1 row_mask:0xf bank_mask:0xf
  v_add_f32_dpp v23, v23, v23 row_ror:1 row_mask:0xf bank_mask:0xf
  v_add_f32_dpp v24, v24, v24 row_ror:1 row_mask:0xf bank_mask:0xf
  v_add_f32_dpp v25, v25, v25 row_ror:1 row_mask:0xf bank_mask:0xf
  v_cvt_pk_bf16_f32 v40, v22, v23
  v_cvt_pk_bf16_f32 v41, v24, v25
  v_lshlrev_b32 v22, 16, v40
  v_and_b32 v23, s80, v40
  v_lshlrev_b32 v24, 16, v41
  v_and_b32 v25, s80, v41
  v_mul_f32 v22, s78, v22
  v_mul_f32 v23, s78, v23
  v_mul_f32 v24, s78, v24
  v_mul_f32 v25, s78, v25
  v_cvt_pk_bf16_f32 v40, v22, v23
  v_cvt_pk_bf16_f32 v41, v24, v25
  v_lshlrev_b32 v22, 16, v40
  v_and_b32 v23, s80, v40
  v_lshlrev_b32 v24, 16, v41
  v_and_b32 v25, s80, v41
  v_max3_f32 v42, v20, v22, v23
  v_max3_f32 v42, v42, v24, v25
  v_sub_f32 v44, v20, v42
  v_mul_f32 v43, s79, v42
  v_mul_f32 v44, s79, v44
  v_fma_f32 v32, v22, s79, -v43
  v_fma_f32 v33, v23, s79, -v43
  v_fma_f32 v34, v24, s79, -v43
  v_fma_f32 v35, v25, s79, -v43
  v_exp_f32 v44, v44
  v_exp_f32 v32, v32
  v_exp_f32 v33, v33
  v_exp_f32 v34, v34
  v_exp_f32 v35, v35
  v_mov_b32 v20, v42
  v_perm_b32 v128, v148, v144, s87
  v_perm_b32 v129, v148, v144, s88
  v_perm_b32 v130, v149, v145, s87
  v_perm_b32 v131, v149, v145, s88
  v_perm_b32 v132, v150, v146, s87
  v_perm_b32 v133, v150, v146, s88
  v_perm_b32 v134, v151, v147, s87
  v_perm_b32 v135, v151, v147, s88
  v_perm_b32 v136, v156, v152, s87
  v_perm_b32 v137, v156, v152, s88
  v_perm_b32 v138, v157, v153, s87
  v_perm_b32 v139, v157, v153, s88
  v_perm_b32 v140, v158, v154, s87
  v_perm_b32 v141, v158, v154, s88
  v_perm_b32 v142, v159, v155, s87
  v_perm_b32 v143, v159, v155, s88
  v_mul_f32 v21, v21, v44
  v_pk_mul_f32 v[12:13], v[12:13], v[44:45] op_sel_hi:[1,0]
  v_pk_mul_f32 v[14:15], v[14:15], v[44:45] op_sel_hi:[1,0]
  v_pk_mul_f32 v[16:17], v[16:17], v[44:45] op_sel_hi:[1,0]
  v_pk_mul_f32 v[18:19], v[18:19], v[44:45] op_sel_hi:[1,0]
  v_cvt_pk_bf16_f32 v36, v32, v33
  v_cvt_pk_bf16_f32 v37, v34, v35
  v_add_f32 v40, v32, v33
  v_add_f32 v41, v34, v35
  v_add_f32 v40, v40, v41
  v_add_f32 v21, v21, v40
  v_dot2_f32_bf16 v12, v128, v36, v12
  v_dot2_f32_bf16 v13, v129, v36, v13
  v_dot2_f32_bf16 v14, v130, v36, v14
  v_dot2_f32_bf16 v15, v131, v36, v15
  v_dot2_f32_bf16 v16, v132, v36, v16
  v_dot2_f32_bf16 v17, v133, v36, v17
  v_dot2_f32_bf16 v18, v134, v36, v18
  v_dot2_f32_bf16 v19, v135, v36, v19
  v_dot2_f32_bf16 v12, v136, v37, v12
  v_dot2_f32_bf16 v13, v137, v37, v13
  v_dot2_f32_bf16 v14, v138, v37, v14
  v_dot2_f32_bf16 v15, v139, v37, v15
  v_dot2_f32_bf16 v16, v140, v37, v16
  v_dot2_f32_bf16 v17, v141, v37, v17
  v_dot2_f32_bf16 v18, v142, v37, v18
  v_dot2_f32_bf16 v19, v143, v37, v19
  s_barrier
  buffer_load_dwordx4 v[128:131], v2, s[28:31], s75 offen offset:0 nt
  buffer_load_dwordx4 v[132:135], v2, s[28:31], s75 offen offset:1024 nt
  buffer_load_dwordx4 v[136:139], v2, s[28:31], s75 offen offset:2048 nt
  buffer_load_dwordx4 v[140:143], v2, s[28:31], s75 offen offset:3072 nt
  buffer_load_dwordx4 v[144:147], v2, s[32:35], s75 offen offset:0 nt
  buffer_load_dwordx4 v[148:151], v2, s[32:35], s75 offen offset:1024 nt
  buffer_load_dwordx4 v[152:155], v2, s[32:35], s75 offen offset:2048 nt
  buffer_load_dwordx4 v[156:159], v2, s[32:35], s75 offen offset:3072 nt
  s_add_u32 s75, s75, 32768
  s_waitcnt vmcnt(24)
  v_dot2_f32_bf16 v22, v160, v8, 0
  v_dot2_f32_bf16 v23, v164, v8, 0
  v_dot2_f32_bf16 v24, v168, v8, 0
  v_dot2_f32_bf16 v25, v172, v8, 0
  v_dot2_f32_bf16 v22, v161, v9, v22
  v_dot2_f32_bf16 v23, v165, v9, v23
  v_dot2_f32_bf16 v24, v169, v9, v24
  v_dot2_f32_bf16 v25, v173, v9, v25
  v_dot2_f32_bf16 v22, v162, v10, v22
  v_dot2_f32_bf16 v23, v166, v10, v23
  v_dot2_f32_bf16 v24, v170, v10, v24
  v_dot2_f32_bf16 v25, v174, v10, v25
  v_dot2_f32_bf16 v22, v163, v11, v22
  v_dot2_f32_bf16 v23, v167, v11, v23
  v_dot2_f32_bf16 v24, v171, v11, v24
  v_dot2_f32_bf16 v25, v175, v11, v25
  v_add_f32_dpp v22, v22, v22 row_ror:8 row_mask:0xf bank_mask:0xf
  v_add_f32_dpp v23, v23, v23 row_ror:8 row_mask:0xf bank_mask:0xf
  v_add_f32_dpp v24, v24, v24 row_ror:8 row_mask:0xf bank_mask:0xf
  v_add_f32_dpp v25, v25, v25 row_ror:8 row_mask:0xf bank_mask:0xf
  v_add_f32_dpp v22, v22, v22 row_ror:4 row_mask:0xf bank_mask:0xf
  v_add_f32_dpp v23, v23, v23 row_ror:4 row_mask:0xf bank_mask:0xf
  v_add_f32_dpp v24, v24, v24 row_ror:4 row_mask:0xf bank_mask:0xf
  v_add_f32_dpp v25, v25, v25 row_ror:4 row_mask:0xf bank_mask:0xf
  v_add_f32_dpp v22, v22, v22 row_ror:2 row_mask:0xf bank_mask:0xf
  v_add_f32_dpp v23, v23, v23 row_ror:2 row_mask:0xf bank_mask:0xf
  v_add_f32_dpp v24, v24, v24 row_ror:2 row_mask:0xf bank_mask:0xf
  v_add_f32_dpp v25, v25, v25 row_ror:2 row_mask:0xf bank_mask:0xf
  v_add_f32_dpp v22, v22, v22 row_ror:1 row_mask:0xf bank_mask:0xf
  v_add_f32_dpp v23, v23, v23 row_ror:1 row_mask:0xf bank_mask:0xf
  v_add_f32_dpp v24, v24, v24 row_ror:1 row_mask:0xf bank_mask:0xf
  v_add_f32_dpp v25, v25, v25 row_ror:1 row_mask:0xf bank_mask:0xf
  v_cvt_pk_bf16_f32 v40, v22, v23
  v_cvt_pk_bf16_f32 v41, v24, v25
  v_lshlrev_b32 v22, 16, v40
  v_and_b32 v23, s80, v40
  v_lshlrev_b32 v24, 16, v41
  v_and_b32 v25, s80, v41
  v_mul_f32 v22, s78, v22
  v_mul_f32 v23, s78, v23
  v_mul_f32 v24, s78, v24
  v_mul_f32 v25, s78, v25
  v_cvt_pk_bf16_f32 v40, v22, v23
  v_cvt_pk_bf16_f32 v41, v24, v25
  v_lshlrev_b32 v22, 16, v40
  v_and_b32 v23, s80, v40
  v_lshlrev_b32 v24, 16, v41
  v_and_b32 v25, s80, v41
  v_max3_f32 v42, v20, v22, v23
  v_max3_f32 v42, v42, v24, v25
  v_sub_f32 v44, v20, v42
  v_mul_f32 v43, s79, v42
  v_mul_f32 v44, s79, v44
  v_fma_f32 v32, v22, s79, -v43
  v_fma_f32 v33, v23, s79, -v43
  v_fma_f32 v34, v24, s79, -v43
  v_fma_f32 v35, v25, s79, -v43
  v_exp_f32 v44, v44
  v_exp_f32 v32, v32
  v_exp_f32 v33, v33
  v_exp_f32 v34, v34
  v_exp_f32 v35, v35
  v_mov_b32 v20, v42
  v_perm_b32 v160, v180, v176, s87
  v_perm_b32 v161, v180, v176, s88
  v_perm_b32 v162, v181, v177, s87
  v_perm_b32 v163, v181, v177, s88
  v_perm_b32 v164, v182, v178, s87
  v_perm_b32 v165, v182, v178, s88
  v_perm_b32 v166, v183, v179, s87
  v_perm_b32 v167, v183, v179, s88
  v_perm_b32 v168, v188, v184, s87
  v_perm_b32 v169, v188, v184, s88
  v_perm_b32 v170, v189, v185, s87
  v_perm_b32 v171, v189, v185, s88
  v_perm_b32 v172, v190, v186, s87
  v_perm_b32 v173, v190, v186, s88
  v_perm_b32 v174, v191, v187, s87
  v_perm_b32 v175, v191, v187, s88
  v_mul_f32 v21, v21, v44
  v_pk_mul_f32 v[12:13], v[12:13], v[44:45] op_sel_hi:[1,0]
  v_pk_mul_f32 v[14:15], v[14:15], v[44:45] op_sel_hi:[1,0]
  v_pk_mul_f32 v[16:17], v[16:17], v[44:45] op_sel_hi:[1,0]
  v_pk_mul_f32 v[18:19], v[18:19], v[44:45] op_sel_hi:[1,0]
  v_cvt_pk_bf16_f32 v36, v32, v33
  v_cvt_pk_bf16_f32 v37, v34, v35
  v_add_f32 v40, v32, v33
  v_add_f32 v41, v34, v35
  v_add_f32 v40, v40, v41
  v_add_f32 v21, v21, v40
  v_dot2_f32_bf16 v12, v160, v36, v12
  v_dot2_f32_bf16 v13, v161, v36, v13
  v_dot2_f32_bf16 v14, v162, v36, v14
  v_dot2_f32_bf16 v15, v163, v36, v15
  v_dot2_f32_bf16 v16, v164, v36, v16
  v_dot2_f32_bf16 v17, v165, v36, v17
  v_dot2_f32_bf16 v18, v166, v36, v18
  v_dot2_f32_bf16 v19, v167, v36, v19
  v_dot2_f32_bf16 v12, v168, v37, v12
  v_dot2_f32_bf16 v13, v169, v37, v13
  v_dot2_f32_bf16 v14, v170, v37, v14
  v_dot2_f32_bf16 v15, v171, v37, v15
  v_dot2_f32_bf16 v16, v172, v37, v16
  v_dot2_f32_bf16 v17, v173, v37, v17
  v_dot2_f32_bf16 v18, v174, v37, v18
  v_dot2_f32_bf16 v19, v175, v37, v19
  buffer_load_dwordx4 v[160:163], v2, s[28:31], s75 offen offset:0 nt
  buffer_load_dwordx4 v[164:167], v2, s[28:31], s75 offen offset:1024 nt
  buffer_load_dwordx4 v[168:171], v2, s[28:31], s75 offen offset:2048 nt
  buffer_load_dwordx4 v[172:175], v2, s[28:31], s75 offen offset:3072 nt
  buffer_load_dwordx4 v[176:179], v2, s[32:35], s75 offen offset:0 nt
  buffer_load_dwordx4 v[180:183], v2, s[32:35], s75 offen offset:1024 nt
  buffer_load_dwordx4 v[184:187], v2, s[32:35], s75 offen offset:2048 nt
  buffer_load_dwordx4 v[188:191], v2, s[32:35], s75 offen offset:3072 nt
  s_add_u32 s75, s75, 32768
  s_waitcnt vmcnt(24)
  v_dot2_f32_bf16 v22, v192, v8, 0
  v_dot2_f32_bf16 v23, v196, v8, 0
  v_dot2_f32_bf16 v24, v200, v8, 0
  v_dot2_f32_bf16 v25, v204, v8, 0
  v_dot2_f32_bf16 v22, v193, v9, v22
  v_dot2_f32_bf16 v23, v197, v9, v23
  v_dot2_f32_bf16 v24, v201, v9, v24
  v_dot2_f32_bf16 v25, v205, v9, v25
  v_dot2_f32_bf16 v22, v194, v10, v22
  v_dot2_f32_bf16 v23, v198, v10, v23
  v_dot2_f32_bf16 v24, v202, v10, v24
  v_dot2_f32_bf16 v25, v206, v10, v25
  v_dot2_f32_bf16 v22, v195, v11, v22
  v_dot2_f32_bf16 v23, v199, v11, v23
  v_dot2_f32_bf16 v24, v203, v11, v24
  v_dot2_f32_bf16 v25, v207, v11, v25
  v_add_f32_dpp v22, v22, v22 row_ror:8 row_mask:0xf bank_mask:0xf
  v_add_f32_dpp v23, v23, v23 row_ror:8 row_mask:0xf bank_mask:0xf
  v_add_f32_dpp v24, v24, v24 row_ror:8 row_mask:0xf bank_mask:0xf
  v_add_f32_dpp v25, v25, v25 row_ror:8 row_mask:0xf bank_mask:0xf
  v_add_f32_dpp v22, v22, v22 row_ror:4 row_mask:0xf bank_mask:0xf
  v_add_f32_dpp v23, v23, v23 row_ror:4 row_mask:0xf bank_mask:0xf
  v_add_f32_dpp v24, v24, v24 row_ror:4 row_mask:0xf bank_mask:0xf
  v_add_f32_dpp v25, v25, v25 row_ror:4 row_mask:0xf bank_mask:0xf
  v_add_f32_dpp v22, v22, v22 row_ror:2 row_mask:0xf bank_mask:0xf
  v_add_f32_dpp v23, v23, v23 row_ror:2 row_mask:0xf bank_mask:0xf
  v_add_f32_dpp v24, v24, v24 row_ror:2 row_mask:0xf bank_mask:0xf
  v_add_f32_dpp v25, v25, v25 row_ror:2 row_mask:0xf bank_mask:0xf
  v_add_f32_dpp v22, v22, v22 row_ror:1 row_mask:0xf bank_mask:0xf
  v_add_f32_dpp v23, v23, v23 row_ror:1 row_mask:0xf bank_mask:0xf
  v_add_f32_dpp v24, v24, v24 row_ror:1 row_mask:0xf bank_mask:0xf
  v_add_f32_dpp v25, v25, v25 row_ror:1 row_mask:0xf bank_mask:0xf
  v_cvt_pk_bf16_f32 v40, v22, v23
  v_cvt_pk_bf16_f32 v41, v24, v25
  v_lshlrev_b32 v22, 16, v40
  v_and_b32 v23, s80, v40
  v_lshlrev_b32 v24, 16, v41
  v_and_b32 v25, s80, v41
  v_mul_f32 v22, s78, v22
  v_mul_f32 v23, s78, v23
  v_mul_f32 v24, s78, v24
  v_mul_f32 v25, s78, v25
  v_cvt_pk_bf16_f32 v40, v22, v23
  v_cvt_pk_bf16_f32 v41, v24, v25
  v_lshlrev_b32 v22, 16, v40
  v_and_b32 v23, s80, v40
  v_lshlrev_b32 v24, 16, v41
  v_and_b32 v25, s80, v41
  v_max3_f32 v42, v20, v22, v23
  v_max3_f32 v42, v42, v24, v25
  v_sub_f32 v44, v20, v42
  v_mul_f32 v43, s79, v42
  v_mul_f32 v44, s79, v44
  v_fma_f32 v32, v22, s79, -v43
  v_fma_f32 v33, v23, s79, -v43
  v_fma_f32 v34, v24, s79, -v43
  v_fma_f32 v35, v25, s79, -v43
  v_exp_f32 v44, v44
  v_exp_f32 v32, v32
  v_exp_f32 v33, v33
  v_exp_f32 v34, v34
  v_exp_f32 v35, v35
  v_mov_b32 v20, v42
  v_perm_b32 v192, v212, v208, s87
  v_perm_b32 v193, v212, v208, s88
  v_perm_b32 v194, v213, v209, s87
  v_perm_b32 v195, v213, v209, s88
  v_perm_b32 v196, v214, v210, s87
  v_perm_b32 v197, v214, v210, s88
  v_perm_b32 v198, v215, v211, s87
  v_perm_b32 v199, v215, v211, s88
  v_perm_b32 v200, v220, v216, s87
  v_perm_b32 v201, v220, v216, s88
  v_perm_b32 v202, v221, v217, s87
  v_perm_b32 v203, v221, v217, s88
  v_perm_b32 v204, v222, v218, s87
  v_perm_b32 v205, v222, v218, s88
  v_perm_b32 v206, v223, v219, s87
  v_perm_b32 v207, v223, v219, s88
  v_mul_f32 v21, v21, v44
  v_pk_mul_f32 v[12:13], v[12:13], v[44:45] op_sel_hi:[1,0]
  v_pk_mul_f32 v[14:15], v[14:15], v[44:45] op_sel_hi:[1,0]
  v_pk_mul_f32 v[16:17], v[16:17], v[44:45] op_sel_hi:[1,0]
  v_pk_mul_f32 v[18:19], v[18:19], v[44:45] op_sel_hi:[1,0]
  v_cvt_pk_bf16_f32 v36, v32, v33
  v_cvt_pk_bf16_f32 v37, v34, v35
  v_add_f32 v40, v32, v33
  v_add_f32 v41, v34, v35
  v_add_f32 v40, v40, v41
  v_add_f32 v21, v21, v40
  v_dot2_f32_bf16 v12, v192, v36, v12
  v_dot2_f32_bf16 v13, v193, v36, v13
  v_dot2_f32_bf16 v14, v194, v36, v14
  v_dot2_f32_bf16 v15, v195, v36, v15
  v_dot2_f32_bf16 v16, v196, v36, v16
  v_dot2_f32_bf16 v17, v197, v36, v17
  v_dot2_f32_bf16 v18, v198, v36, v18
  v_dot2_f32_bf16 v19, v199, v36, v19
  v_dot2_f32_bf16 v12, v200, v37, v12
  v_dot2_f32_bf16 v13, v201, v37, v13
  v_dot2_f32_bf16 v14, v202, v37, v14
  v_dot2_f32_bf16 v15, v203, v37, v15
  v_dot2_f32_bf16 v16, v204, v37, v16
  v_dot2_f32_bf16 v17, v205, v37, v17
  v_dot2_f32_bf16 v18, v206, v37, v18
  v_dot2_f32_bf16 v19, v207, v37, v19
  buffer_load_dwordx4 v[192:195], v2, s[28:31], s75 offen offset:0 nt
  buffer_load_dwordx4 v[196:199], v2, s[28:31], s75 offen offset:1024 nt
  buffer_load_dwordx4 v[200:203], v2, s[28:31], s75 offen offset:2048 nt
  buffer_load_dwordx4 v[204:207], v2, s[28:31], s75 offen offset:3072 nt
  buffer_load_dwordx4 v[208:211], v2, s[32:35], s75 offen offset:0 nt
  buffer_load_dwordx4 v[212:215], v2, s[32:35], s75 offen offset:1024 nt
  buffer_load_dwordx4 v[216:219], v2, s[32:35], s75 offen offset:2048 nt
  buffer_load_dwordx4 v[220:223], v2, s[32:35], s75 offen offset:3072 nt
  s_add_u32 s75, s75, 32768
  s_waitcnt vmcnt(24)
  v_dot2_f32_bf16 v22, v224, v8, 0
  v_dot2_f32_bf16 v23, v228, v8, 0
  v_dot2_f32_bf16 v24, v232, v8, 0
  v_dot2_f32_bf16 v25, v236, v8, 0
  v_dot2_f32_bf16 v22, v225, v9, v22
  v_dot2_f32_bf16 v23, v229, v9, v23
  v_dot2_f32_bf16 v24, v233, v9, v24
  v_dot2_f32_bf16 v25, v237, v9, v25
  v_dot2_f32_bf16 v22, v226, v10, v22
  v_dot2_f32_bf16 v23, v230, v10, v23
  v_dot2_f32_bf16 v24, v234, v10, v24
  v_dot2_f32_bf16 v25, v238, v10, v25
  v_dot2_f32_bf16 v22, v227, v11, v22
  v_dot2_f32_bf16 v23, v231, v11, v23
  v_dot2_f32_bf16 v24, v235, v11, v24
  v_dot2_f32_bf16 v25, v239, v11, v25
  v_add_f32_dpp v22, v22, v22 row_ror:8 row_mask:0xf bank_mask:0xf
  v_add_f32_dpp v23, v23, v23 row_ror:8 row_mask:0xf bank_mask:0xf
  v_add_f32_dpp v24, v24, v24 row_ror:8 row_mask:0xf bank_mask:0xf
  v_add_f32_dpp v25, v25, v25 row_ror:8 row_mask:0xf bank_mask:0xf
  v_add_f32_dpp v22, v22, v22 row_ror:4 row_mask:0xf bank_mask:0xf
  v_add_f32_dpp v23, v23, v23 row_ror:4 row_mask:0xf bank_mask:0xf
  v_add_f32_dpp v24, v24, v24 row_ror:4 row_mask:0xf bank_mask:0xf
  v_add_f32_dpp v25, v25, v25 row_ror:4 row_mask:0xf bank_mask:0xf
  v_add_f32_dpp v22, v22, v22 row_ror:2 row_mask:0xf bank_mask:0xf
  v_add_f32_dpp v23, v23, v23 row_ror:2 row_mask:0xf bank_mask:0xf
  v_add_f32_dpp v24, v24, v24 row_ror:2 row_mask:0xf bank_mask:0xf
  v_add_f32_dpp v25, v25, v25 row_ror:2 row_mask:0xf bank_mask:0xf
  v_add_f32_dpp v22, v22, v22 row_ror:1 row_mask:0xf bank_mask:0xf
  v_add_f32_dpp v23, v23, v23 row_ror:1 row_mask:0xf bank_mask:0xf
  v_add_f32_dpp v24, v24, v24 row_ror:1 row_mask:0xf bank_mask:0xf
  v_add_f32_dpp v25, v25, v25 row_ror:1 row_mask:0xf bank_mask:0xf
  v_cvt_pk_bf16_f32 v40, v22, v23
  v_cvt_pk_bf16_f32 v41, v24, v25
  v_lshlrev_b32 v22, 16, v40
  v_and_b32 v23, s80, v40
  v_lshlrev_b32 v24, 16, v41
  v_and_b32 v25, s80, v41
  v_mul_f32 v22, s78, v22
  v_mul_f32 v23, s78, v23
  v_mul_f32 v24, s78, v24
  v_mul_f32 v25, s78, v25
  v_cvt_pk_bf16_f32 v40, v22, v23
  v_cvt_pk_bf16_f32 v41, v24, v25
  v_lshlrev_b32 v22, 16, v40
  v_and_b32 v23, s80, v40
  v_lshlrev_b32 v24, 16, v41
  v_and_b32 v25, s80, v41
  v_max3_f32 v42, v20, v22, v23
  v_max3_f32 v42, v42, v24, v25
  v_sub_f32 v44, v20, v42
  v_mul_f32 v43, s79, v42
  v_mul_f32 v44, s79, v44
  v_fma_f32 v32, v22, s79, -v43
  v_fma_f32 v33, v23, s79, -v43
  v_fma_f32 v34, v24, s79, -v43
  v_fma_f32 v35, v25, s79, -v43
  v_exp_f32 v44, v44
  v_exp_f32 v32, v32
  v_exp_f32 v33, v33
  v_exp_f32 v34, v34
  v_exp_f32 v35, v35
  v_mov_b32 v20, v42
  v_perm_b32 v224, v244, v240, s87
  v_perm_b32 v225, v244, v240, s88
  v_perm_b32 v226, v245, v241, s87
  v_perm_b32 v227, v245, v241, s88
  v_perm_b32 v228, v246, v242, s87
  v_perm_b32 v229, v246, v242, s88
  v_perm_b32 v230, v247, v243, s87
  v_perm_b32 v231, v247, v243, s88
  v_perm_b32 v232, v252, v248, s87
  v_perm_b32 v233, v252, v248, s88
  v_perm_b32 v234, v253, v249, s87
  v_perm_b32 v235, v253, v249, s88
  v_perm_b32 v236, v254, v250, s87
  v_perm_b32 v237, v254, v250, s88
  v_perm_b32 v238, v255, v251, s87
  v_perm_b32 v239, v255, v251, s88
  v_mul_f32 v21, v21, v44
  v_pk_mul_f32 v[12:13], v[12:13], v[44:45] op_sel_hi:[1,0]
  v_pk_mul_f32 v[14:15], v[14:15], v[44:45] op_sel_hi:[1,0]
  v_pk_mul_f32 v[16:17], v[16:17], v[44:45] op_sel_hi:[1,0]
  v_pk_mul_f32 v[18:19], v[18:19], v[44:45] op_sel_hi:[1,0]
  v_cvt_pk_bf16_f32 v36, v32, v33
  v_cvt_pk_bf16_f32 v37, v34, v35
  v_add_f32 v40, v32, v33
  v_add_f32 v41, v34, v35
  v_add_f32 v40, v40, v41
  v_add_f32 v21, v21, v40
  v_dot2_f32_bf16 v12, v224, v36, v12
  v_dot2_f32_bf16 v13, v225, v36, v13
  v_dot2_f32_bf16 v14, v226, v36, v14
  v_dot2_f32_bf16 v15, v227, v36, v15
  v_dot2_f32_bf16 v16, v228, v36, v16
  v_dot2_f32_bf16 v17, v229, v36, v17
  v_dot2_f32_bf16 v18, v230, v36, v18
  v_dot2_f32_bf16 v19, v231, v36, v19
  v_dot2_f32_bf16 v12, v232, v37, v12
  v_dot2_f32_bf16 v13, v233, v37, v13
  v_dot2_f32_bf16 v14, v234, v37, v14
  v_dot2_f32_bf16 v15, v235, v37, v15
  v_dot2_f32_bf16 v16, v236, v37, v16
  v_dot2_f32_bf16 v17, v237, v37, v17
  v_dot2_f32_bf16 v18, v238, v37, v18
  v_dot2_f32_bf16 v19, v239, v37, v19
  buffer_load_dwordx4 v[224:227], v2, s[28:31], s75 offen offset:0 nt
  buffer_load_dwordx4 v[228:231], v2, s[28:31], s75 offen offset:1024 nt
  buffer_load_dwordx4 v[232:235], v2, s[28:31], s75 offen offset:2048 nt
  buffer_load_dwordx4 v[236:239], v2, s[28:31], s75 offen offset:3072 nt
  buffer_load_dwordx4 v[240:243], v2, s[32:35], s75 offen offset:0 nt
  buffer_load_dwordx4 v[244:247], v2, s[32:35], s75 offen offset:1024 nt
  buffer_load_dwordx4 v[248:251], v2, s[32:35], s75 offen offset:2048 nt
  buffer_load_dwordx4 v[252:255], v2, s[32:35], s75 offen offset:3072 nt
  s_add_u32 s75, s75, 32768
  s_sub_u32 s76, s76, 1
  s_cmp_lg_u32 s76, 1
  s_cbranch_scc1 L_nochk
  v_lshlrev_b32 v62, 2, v1
  v_and_b32 v62, 0x7f, v62
  buffer_load_dword v63, v62, s[68:71], 0 offen sc0 sc1
L_nochk:
  s_cmp_lg_u32 s76, 0
  s_cbranch_scc1 L_loop
  s_waitcnt vmcnt(24)
  v_dot2_f32_bf16 v22, v128, v8, 0
  v_dot2_f32_bf16 v23, v132, v8, 0
  v_dot2_f32_bf16 v24, v136, v8, 0
  v_dot2_f32_bf16 v25, v140, v8, 0
  v_dot2_f32_bf16 v22, v129, v9, v22
  v_dot2_f32_bf16 v23, v133, v9, v23
  v_dot2_f32_bf16 v24, v137, v9, v24
  v_dot2_f32_bf16 v25, v141, v9, v25
  v_dot2_f32_bf16 v22, v130, v10, v22
  v_dot2_f32_bf16 v23, v134, v10, v23
  v_dot2_f32_bf16 v24, v138, v10, v24
  v_dot2_f32_bf16 v25, v142, v10, v25
  v_dot2_f32_bf16 v22, v131, v11, v22
  v_dot2_f32_bf16 v23, v135, v11, v23
  v_dot2_f32_bf16 v24, v139, v11, v24
  v_dot2_f32_bf16 v25, v143, v11, v25
  v_add_f32_dpp v22, v22, v22 row_ror:8 row_mask:0xf bank_mask:0xf
  v_add_f32_dpp v23, v23, v23 row_ror:8 row_mask:0xf bank_mask:0xf
  v_add_f32_dpp v24, v24, v24 row_ror:8 row_mask:0xf bank_mask:0xf
  v_add_f32_dpp v25, v25, v25 row_ror:8 row_mask:0xf bank_mask:0xf
  v_add_f32_dpp v22, v22, v22 row_ror:4 row_mask:0xf bank_mask:0xf
  v_add_f32_dpp v23, v23, v23 row_ror:4 row_mask:0xf bank_mask:0xf
  v_add_f32_dpp v24, v24, v24 row_ror:4 row_mask:0xf bank_mask:0xf
  v_add_f32_dpp v25, v25, v25 row_ror:4 row_mask:0xf bank_mask:0xf
  v_add_f32_dpp v22, v22, v22 row_ror:2 row_mask:0xf bank_mask:0xf
  v_add_f32_dpp v23, v23, v23 row_ror:2 row_mask:0xf bank_mask:0xf
  v_add_f32_dpp v24, v24, v24 row_ror:2 row_mask:0xf bank_mask:0xf
  v_add_f32_dpp v25, v25, v25 row_ror:2 row_mask:0xf bank_mask:0xf
  v_add_f32_dpp v22, v22, v22 row_ror:1 row_mask:0xf bank_mask:0xf
  v_add_f32_dpp v23, v23, v23 row_ror:1 row_mask:0xf bank_mask:0xf
  v_add_f32_dpp v24, v24, v24 row_ror:1 row_mask:0xf bank_mask:0xf
  v_add_f32_dpp v25, v25, v25 row_ror:1 row_mask:0xf bank_mask:0xf
  v_cvt_pk_bf16_f32 v40, v22, v23
  v_cvt_pk_bf16_f32 v41, v24, v25
  v_lshlrev_b32 v22, 16, v40
  v_and_b32 v23, s80, v40
  v_lshlrev_b32 v24, 16, v41
  v_and_b32 v25, s80, v41
  v_mul_f32 v22, s78, v22
  v_mul_f32 v23, s78, v23
  v_mul_f32 v24, s78, v24
  v_mul_f32 v25, s78, v25
  v_cvt_pk_bf16_f32 v40, v22, v23
  v_cvt_pk_bf16_f32 v41, v24, v25
  v_lshlrev_b32 v22, 16, v40
  v_and_b32 v23, s80, v40
  v_lshlrev_b32 v24, 16, v41
  v_and_b32 v25, s80, v41
  v_max3_f32 v42, v20, v22, v23
  v_max3_f32 v42, v42, v24, v25
  v_sub_f32 v44, v20, v42
  v_mul_f32 v43, s79, v42
  v_mul_f32 v44, s79, v44
  v_fma_f32 v32, v22, s79, -v43
  v_fma_f32 v33, v23, s79, -v43
  v_fma_f32 v34, v24, s79, -v43
  v_fma_f32 v35, v25, s79, -v43
  v_exp_f32 v44, v44
  v_exp_f32 v32, v32
  v_exp_f32 v33, v33
  v_exp_f32 v34, v34
  v_exp_f32 v35, v35
  v_mov_b32 v20, v42
  v_perm_b32 v128, v148, v144, s87
  v_perm_b32 v129, v148, v144, s88
  v_perm_b32 v130, v149, v145, s87
  v_perm_b32 v131, v149, v145, s88
  v_perm_b32 v132, v150, v146, s87
  v_perm_b32 v133, v150, v146, s88
  v_perm_b32 v134, v151, v147, s87
  v_perm_b32 v135, v151, v147, s88
  v_perm_b32 v136, v156, v152, s87
  v_perm_b32 v137, v156, v152, s88
  v_perm_b32 v138, v157, v153, s87
  v_perm_b32 v139, v157, v153, s88
  v_perm_b32 v140, v158, v154, s87
  v_perm_b32 v141, v158, v154, s88
  v_perm_b32 v142, v159, v155, s87
  v_perm_b32 v143, v159, v155, s88
  v_mul_f32 v21, v21, v44
  v_pk_mul_f32 v[12:13], v[12:13], v[44:45] op_sel_hi:[1,0]
  v_pk_mul_f32 v[14:15], v[14:15], v[44:45] op_sel_hi:[1,0]
  v_pk_mul_f32 v[16:17], v[16:17], v[44:45] op_sel_hi:[1,0]
  v_pk_mul_f32 v[18:19], v[18:19], v[44:45] op_sel_hi:[1,0]
  v_cvt_pk_bf16_f32 v36, v32, v33
  v_cvt_pk_bf16_f32 v37, v34, v35
  v_add_f32 v40, v32, v33
  v_add_f32 v41, v34, v35
  v_add_f32 v40, v40, v41
  v_add_f32 v21, v21, v40
  v_dot2_f32_bf16 v12, v128, v36, v12
  v_dot2_f32_bf16 v13, v129, v36, v13
  v_dot2_f32_bf16 v14, v130, v36, v14
  v_dot2_f32_bf16 v15, v131, v36, v15
  v_dot2_f32_bf16 v16, v132, v36, v16
  v_dot2_f32_bf16 v17, v133, v36, v17
  v_dot2_f32_bf16 v18, v134, v36, v18
  v_dot2_f32_bf16 v19, v135, v36, v19
  v_dot2_f32_bf16 v12, v136, v37, v12
  v_dot2_f32_bf16 v13, v137, v37, v13
  v_dot2_f32_bf16 v14, v138, v37, v14
  v_dot2_f32_bf16 v15, v139, v37, v15
  v_dot2_f32_bf16 v16, v140, v37, v16
  v_dot2_f32_bf16 v17, v141, v37, v17
  v_dot2_f32_bf16 v18, v142, v37, v18
  v_dot2_f32_bf16 v19, v143, v37, v19
  s_waitcnt vmcnt(16)
  v_dot2_f32_bf16 v22, v160, v8, 0
  v_dot2_f32_bf16 v23, v164, v8, 0
  v_dot2_f32_bf16 v24, v168, v8, 0
  v_dot2_f32_bf16 v25, v172, v8, 0
  v_dot2_f32_bf16 v22, v161, v9, v22
  v_dot2_f32_bf16 v23, v165, v9, v23
  v_dot2_f32_bf16 v24, v169, v9, v24
  v_dot2_f32_bf16 v25, v173, v9, v25
  v_dot2_f32_bf16 v22, v162, v10, v22
  v_dot2_f32_bf16 v23, v166, v10, v23
  v_dot2_f32_bf16 v24, v170, v10, v24
  v_dot2_f32_bf16 v25, v174, v10, v25
  v_dot2_f32_bf16 v22, v163, v11, v22
  v_dot2_f32_bf16 v23, v167, v11, v23
  v_dot2_f32_bf16 v24, v171, v11, v24
  v_dot2_f32_bf16 v25, v175, v11, v25
  v_add_f32_dpp v22, v22, v22 row_ror:8 row_mask:0xf bank_mask:0xf
  v_add_f32_dpp v23, v23, v23 row_ror:8 row_mask:0xf bank_mask:0xf
  v_add_f32_dpp v24, v24, v24 row_ror:8 row_mask:0xf bank_mask:0xf
  v_add_f32_dpp v25, v25, v25 row_ror:8 row_mask:0xf bank_mask:0xf
  v_add_f32_dpp v22, v22, v22 row_ror:4 row_mask:0xf bank_mask:0xf
  v_add_f32_dpp v23, v23, v23 row_ror:4 row_mask:0xf bank_mask:0xf
  v_add_f32_dpp v24, v24, v24 row_ror:4 row_mask:0xf bank_mask:0xf
  v_add_f32_dpp v25, v25, v25 row_ror:4 row_mask:0xf bank_mask:0xf
  v_add_f32_dpp v22, v22, v22 row_ror:2 row_mask:0xf bank_mask:0xf
  v_add_f32_dpp v23, v23, v23 row_ror:2 row_mask:0xf bank_mask:0xf
  v_add_f32_dpp v24, v24, v24 row_ror:2 row_mask:0xf bank_mask:0xf
  v_add_f32_dpp v25, v25, v25 row_ror:2 row_mask:0xf bank_mask:0xf
  v_add_f32_dpp v22, v22, v22 row_ror:1 row_mask:0xf bank_mask:0xf
  v_add_f32_dpp v23, v23, v23 row_ror:1 row_mask:0xf bank_mask:0xf
  v_add_f32_dpp v24, v24, v24 row_ror:1 row_mask:0xf bank_mask:0xf
  v_add_f32_dpp v25, v25, v25 row_ror:1 row_mask:0xf bank_mask:0xf
  v_cvt_pk_bf16_f32 v40, v22, v23
  v_cvt_pk_bf16_f32 v41, v24, v25
  v_lshlrev_b32 v22, 16, v40
  v_and_b32 v23, s80, v40
  v_lshlrev_b32 v24, 16, v41
  v_and_b32 v25, s80, v41
  v_mul_f32 v22, s78, v22
  v_mul_f32 v23, s78, v23
  v_mul_f32 v24, s78, v24
  v_mul_f32 v25, s78, v25
  v_cvt_pk_bf16_f32 v40, v22, v23
  v_cvt_pk_bf16_f32 v41, v24, v25
  v_lshlrev_b32 v22, 16, v40
  v_and_b32 v23, s80, v40
  v_lshlrev_b32 v24, 16, v41
  v_and_b32 v25, s80, v41
  v_max3_f32 v42, v20, v22, v23
  v_max3_f32 v42, v42, v24, v25
  v_sub_f32 v44, v20, v42
  v_mul_f32 v43, s79, v42
  v_mul_f32 v44, s79, v44
  v_fma_f32 v32, v22, s79, -v43
  v_fma_f32 v33, v23, s79, -v43
  v_fma_f32 v34, v24, s79, -v43
  v_fma_f32 v35, v25, s79, -v43
  v_exp_f32 v44, v44
  v_exp_f32 v32, v32
  v_exp_f32 v33, v33
  v_exp_f32 v34, v34
  v_exp_f32 v35, v35
  v_mov_b32 v20, v42
  v_perm_b32 v160, v180, v176, s87
  v_perm_b32 v161, v180, v176, s88
  v_perm_b32 v162, v181, v177, s87
  v_perm_b32 v163, v181, v177, s88
  v_perm_b32 v164, v182, v178, s87
  v_perm_b32 v165, v182, v178, s88
  v_perm_b32 v166, v183, v179, s87
  v_perm_b32 v167, v183, v179, s88
  v_perm_b32 v168, v188, v184, s87
  v_perm_b32 v169, v188, v184, s88
  v_perm_b32 v170, v189, v185, s87
  v_perm_b32 v171, v189, v185, s88
  v_perm_b32 v172, v190, v186, s87
  v_perm_b32 v173, v190, v186, s88
  v_perm_b32 v174, v191, v187, s87
  v_perm_b32 v175, v191, v187, s88
  v_mul_f32 v21, v21, v44
  v_pk_mul_f32 v[12:13], v[12:13], v[44:45] op_sel_hi:[1,0]
  v_pk_mul_f32 v[14:15], v[14:15], v[44:45] op_sel_hi:[1,0]
  v_pk_mul_f32 v[16:17], v[16:17], v[44:45] op_sel_hi:[1,0]
  v_pk_mul_f32 v[18:19], v[18:19], v[44:45] op_sel_hi:[1,0]
  v_cvt_pk_bf16_f32 v36, v32, v33
  v_cvt_pk_bf16_f32 v37, v34, v35
  v_add_f32 v40, v32, v33
  v_add_f32 v41, v34, v35
  v_add_f32 v40, v40, v41
  v_add_f32 v21, v21, v40
  v_dot2_f32_bf16 v12, v160, v36, v12
  v_dot2_f32_bf16 v13, v161, v36, v13
  v_dot2_f32_bf16 v14, v162, v36, v14
  v_dot2_f32_bf16 v15, v163, v36, v15
  v_dot2_f32_bf16 v16, v164, v36, v16
  v_dot2_f32_bf16 v17, v165, v36, v17
  v_dot2_f32_bf16 v18, v166, v36, v18
  v_dot2_f32_bf16 v19, v167, v36, v19
  v_dot2_f32_bf16 v12, v168, v37, v12
  v_dot2_f32_bf16 v13, v169, v37, v13
  v_dot2_f32_bf16 v14, v170, v37, v14
  v_dot2_f32_bf16 v15, v171, v37, v15
  v_dot2_f32_bf16 v16, v172, v37, v16
  v_dot2_f32_bf16 v17, v173, v37, v17
  v_dot2_f32_bf16 v18, v174, v37, v18
  v_dot2_f32_bf16 v19, v175, v37, v19
  s_waitcnt vmcnt(8)
  v_dot2_f32_bf16 v22, v192, v8, 0
  v_dot2_f32_bf16 v23, v196, v8, 0
  v_dot2_f32_bf16 v24, v200, v8, 0
  v_dot2_f32_bf16 v25, v204, v8, 0
  v_dot2_f32_bf16 v22, v193, v9, v22
  v_dot2_f32_bf16 v23, v197, v9, v23
  v_dot2_f32_bf16 v24, v201, v9, v24
  v_dot2_f32_bf16 v25, v205, v9, v25
  v_dot2_f32_bf16 v22, v194, v10, v22
  v_dot2_f32_bf16 v23, v198, v10, v23
  v_dot2_f32_bf16 v24, v202, v10, v24
  v_dot2_f32_bf16 v25, v206, v10, v25
  v_dot2_f32_bf16 v22, v195, v11, v22
  v_dot2_f32_bf16 v23, v199, v11, v23
  v_dot2_f32_bf16 v24, v203, v11, v24
  v_dot2_f32_bf16 v25, v207, v11, v25
  v_add_f32_dpp v22, v22, v22 row_ror:8 row_mask:0xf bank_mask:0xf
  v_add_f32_dpp v23, v23, v23 row_ror:8 row_mask:0xf bank_mask:0xf
  v_add_f32_dpp v24, v24, v24 row_ror:8 row_mask:0xf bank_mask:0xf
  v_add_f32_dpp v25, v25, v25 row_ror:8 row_mask:0xf bank_mask:0xf
  v_add_f32_dpp v22, v22, v22 row_ror:4 row_mask:0xf bank_mask:0xf
  v_add_f32_dpp v23, v23, v23 row_ror:4 row_mask:0xf bank_mask:0xf
  v_add_f32_dpp v24, v24, v24 row_ror:4 row_mask:0xf bank_mask:0xf
  v_add_f32_dpp v25, v25, v25 row_ror:4 row_mask:0xf bank_mask:0xf
  v_add_f32_dpp v22, v22, v22 row_ror:2 row_mask:0xf bank_mask:0xf
  v_add_f32_dpp v23, v23, v23 row_ror:2 row_mask:0xf bank_mask:0xf
  v_add_f32_dpp v24, v24, v24 row_ror:2 row_mask:0xf bank_mask:0xf
  v_add_f32_dpp v25, v25, v25 row_ror:2 row_mask:0xf bank_mask:0xf
  v_add_f32_dpp v22, v22, v22 row_ror:1 row_mask:0xf bank_mask:0xf
  v_add_f32_dpp v23, v23, v23 row_ror:1 row_mask:0xf bank_mask:0xf
  v_add_f32_dpp v24, v24, v24 row_ror:1 row_mask:0xf bank_mask:0xf
  v_add_f32_dpp v25, v25, v25 row_ror:1 row_mask:0xf bank_mask:0xf
  v_cvt_pk_bf16_f32 v40, v22, v23
  v_cvt_pk_bf16_f32 v41, v24, v25
  v_lshlrev_b32 v22, 16, v40
  v_and_b32 v23, s80, v40
  v_lshlrev_b32 v24, 16, v41
  v_and_b32 v25, s80, v41
  v_mul_f32 v22, s78, v22
  v_mul_f32 v23, s78, v23
  v_mul_f32 v24, s78, v24
  v_mul_f32 v25, s78, v25
  v_cvt_pk_bf16_f32 v40, v22, v23
  v_cvt_pk_bf16_f32 v41, v24, v25
  v_lshlrev_b32 v22, 16, v40
  v_and_b32 v23, s80, v40
  v_lshlrev_b32 v24, 16, v41
  v_and_b32 v25, s80, v41
  v_max3_f32 v42, v20, v22, v23
  v_max3_f32 v42, v42, v24, v25
  v_sub_f32 v44, v20, v42
  v_mul_f32 v43, s79, v42
  v_mul_f32 v44, s79, v44
  v_fma_f32 v32, v22, s79, -v43
  v_fma_f32 v33, v23, s79, -v43
  v_fma_f32 v34, v24, s79, -v43
  v_fma_f32 v35, v25, s79, -v43
  v_exp_f32 v44, v44
  v_exp_f32 v32, v32
  v_exp_f32 v33, v33
  v_exp_f32 v34, v34
  v_exp_f32 v35, v35
  v_mov_b32 v20, v42
  v_perm_b32 v192, v212, v208, s87
  v_perm_b32 v193, v212, v208, s88
  v_perm_b32 v194, v213, v209, s87
  v_perm_b32 v195, v213, v209, s88
  v_perm_b32 v196, v214, v210, s87
  v_perm_b32 v197, v214, v210, s88
  v_perm_b32 v198, v215, v211, s87
  v_perm_b32 v199, v215, v211, s88
  v_perm_b32 v200, v220, v216, s87
  v_perm_b32 v201, v220, v216, s88
  v_perm_b32 v202, v221, v217, s87
  v_perm_b32 v203, v221, v217, s88
  v_perm_b32 v204, v222, v218, s87
  v_perm_b32 v205, v222, v218, s88
  v_perm_b32 v206, v223, v219, s87
  v_perm_b32 v207, v223, v219, s88
  v_mul_f32 v21, v21, v44
  v_pk_mul_f32 v[12:13], v[12:13], v[44:45] op_sel_hi:[1,0]
  v_pk_mul_f32 v[14:15], v[14:15], v[44:45] op_sel_hi:[1,0]
  v_pk_mul_f32 v[16:17], v[16:17], v[44:45] op_sel_hi:[1,0]
  v_pk_mul_f32 v[18:19], v[18:19], v[44:45] op_sel_hi:[1,0]
  v_cvt_pk_bf16_f32 v36, v32, v33
  v_cvt_pk_bf16_f32 v37, v34, v35
  v_add_f32 v40, v32, v33
  v_add_f32 v41, v34, v35
  v_add_f32 v40, v40, v41
  v_add_f32 v21, v21, v40
  v_dot2_f32_bf16 v12, v192, v36, v12
  v_dot2_f32_bf16 v13, v193, v36, v13
  v_dot2_f32_bf16 v14, v194, v36, v14
  v_dot2_f32_bf16 v15, v195, v36, v15
  v_dot2_f32_bf16 v16, v196, v36, v16
  v_dot2_f32_bf16 v17, v197, v36, v17
  v_dot2_f32_bf16 v18, v198, v36, v18
  v_dot2_f32_bf16 v19, v199, v36, v19
  v_dot2_f32_bf16 v12, v200, v37, v12
  v_dot2_f32_bf16 v13, v201, v37, v13
  v_dot2_f32_bf16 v14, v202, v37, v14
  v_dot2_f32_bf16 v15, v203, v37, v15
  v_dot2_f32_bf16 v16, v204, v37, v16
  v_dot2_f32_bf16 v17, v205, v37, v17
  v_dot2_f32_bf16 v18, v206, v37, v18
  v_dot2_f32_bf16 v19, v207, v37, v19
  s_waitcnt vmcnt(0)
  v_dot2_f32_bf16 v22, v224, v8, 0
  v_dot2_f32_bf16 v23, v228, v8, 0
  v_dot2_f32_bf16 v24, v232, v8, 0
  v_dot2_f32_bf16 v25, v236, v8, 0
  v_dot2_f32_bf16 v22, v225, v9, v22
  v_dot2_f32_bf16 v23, v229, v9, v23
  v_dot2_f32_bf16 v24, v233, v9, v24
  v_dot2_f32_bf16 v25, v237, v9, v25
  v_dot2_f32_bf16 v22, v226, v10, v22
  v_dot2_f32_bf16 v23, v230, v10, v23
  v_dot2_f32_bf16 v24, v234, v10, v24
  v_dot2_f32_bf16 v25, v238, v10, v25
  v_dot2_f32_bf16 v22, v227, v11, v22
  v_dot2_f32_bf16 v23, v231, v11, v23
  v_dot2_f32_bf16 v24, v235, v11, v24
  v_dot2_f32_bf16 v25, v239, v11, v25
  v_add_f32_dpp v22, v22, v22 row_ror:8 row_mask:0xf bank_mask:0xf
  v_add_f32_dpp v23, v23, v23 row_ror:8 row_mask:0xf bank_mask:0xf
  v_add_f32_dpp v24, v24, v24 row_ror:8 row_mask:0xf bank_mask:0xf
  v_add_f32_dpp v25, v25, v25 row_ror:8 row_mask:0xf bank_mask:0xf
  v_add_f32_dpp v22, v22, v22 row_ror:4 row_mask:0xf bank_mask:0xf
  v_add_f32_dpp v23, v23, v23 row_ror:4 row_mask:0xf bank_mask:0xf
  v_add_f32_dpp v24, v24, v24 row_ror:4 row_mask:0xf bank_mask:0xf
  v_add_f32_dpp v25, v25, v25 row_ror:4 row_mask:0xf bank_mask:0xf
  v_add_f32_dpp v22, v22, v22 row_ror:2 row_mask:0xf bank_mask:0xf
  v_add_f32_dpp v23, v23, v23 row_ror:2 row_mask:0xf bank_mask:0xf
  v_add_f32_dpp v24, v24, v24 row_ror:2 row_mask:0xf bank_mask:0xf
  v_add_f32_dpp v25, v25, v25 row_ror:2 row_mask:0xf bank_mask:0xf
  v_add_f32_dpp v22, v22, v22 row_ror:1 row_mask:0xf bank_mask:0xf
  v_add_f32_dpp v23, v23, v23 row_ror:1 row_mask:0xf bank_mask:0xf
  v_add_f32_dpp v24, v24, v24 row_ror:1 row_mask:0xf bank_mask:0xf
  v_add_f32_dpp v25, v25, v25 row_ror:1 row_mask:0xf bank_mask:0xf
  v_cvt_pk_bf16_f32 v40, v22, v23
  v_cvt_pk_bf16_f32 v41, v24, v25
  v_lshlrev_b32 v22, 16, v40
  v_and_b32 v23, s80, v40
  v_lshlrev_b32 v24, 16, v41
  v_and_b32 v25, s80, v41
  v_mul_f32 v22, s78, v22
  v_mul_f32 v23, s78, v23
  v_mul_f32 v24, s78, v24
  v_mul_f32 v25, s78, v25
  v_cvt_pk_bf16_f32 v40, v22, v23
  v_cvt_pk_bf16_f32 v41, v24, v25
  v_lshlrev_b32 v22, 16, v40
  v_and_b32 v23, s80, v40
  v_lshlrev_b32 v24, 16, v41
  v_and_b32 v25, s80, v41
  v_max3_f32 v42, v20, v22, v23
  v_max3_f32 v42, v42, v24, v25
  v_sub_f32 v44, v20, v42
  v_mul_f32 v43, s79, v42
  v_mul_f32 v44, s79, v44
  v_fma_f32 v32, v22, s79, -v43
  v_fma_f32 v33, v23, s79, -v43
  v_fma_f32 v34, v24, s79, -v43
  v_fma_f32 v35, v25, s79, -v43
  v_exp_f32 v44, v44
  v_exp_f32 v32, v32
  v_exp_f32 v33, v33
  v_exp_f32 v34, v34
  v_exp_f32 v35, v35
  v_mov_b32 v20, v42
  v_perm_b32 v224, v244, v240, s87
  v_perm_b32 v225, v244, v240, s88
  v_perm_b32 v226, v245, v241, s87
  v_perm_b32 v227, v245, v241, s88
  v_perm_b32 v228, v246, v242, s87
  v_perm_b32 v229, v246, v242, s88
  v_perm_b32 v230, v247, v243, s87
  v_perm_b32 v231, v247, v243, s88
  v_perm_b32 v232, v252, v248, s87
  v_perm_b32 v233, v252, v248, s88
  v_perm_b32 v234, v253, v249, s87
  v_perm_b32 v235, v253, v249, s88
  v_perm_b32 v236, v254, v250, s87
  v_perm_b32 v237, v254, v250, s88
  v_perm_b32 v238, v255, v251, s87
  v_perm_b32 v239, v255, v251, s88
  v_mul_f32 v21, v21, v44
  v_pk_mul_f32 v[12:13], v[12:13], v[44:45] op_sel_hi:[1,0]
  v_pk_mul_f32 v[14:15], v[14:15], v[44:45] op_sel_hi:[1,0]
  v_pk_mul_f32 v[16:17], v[16:17], v[44:45] op_sel_hi:[1,0]
  v_pk_mul_f32 v[18:19], v[18:19], v[44:45] op_sel_hi:[1,0]
  v_cvt_pk_bf16_f32 v36, v32, v33
  v_cvt_pk_bf16_f32 v37, v34, v35
  v_add_f32 v40, v32, v33
  v_add_f32 v41, v34, v35
  v_add_f32 v40, v40, v41
  v_add_f32 v21, v21, v40
  v_dot2_f32_bf16 v12, v224, v36, v12
  v_dot2_f32_bf16 v13, v225, v36, v13
  v_dot2_f32_bf16 v14, v226, v36, v14
  v_dot2_f32_bf16 v15, v227, v36, v15
  v_dot2_f32_bf16 v16, v228, v36, v16
  v_dot2_f32_bf16 v17, v229, v36, v17
  v_dot2_f32_bf16 v18, v230, v36, v18
  v_dot2_f32_bf16 v19, v231, v36, v19
  v_dot2_f32_bf16 v12, v232, v37, v12
  v_dot2_f32_bf16 v13, v233, v37, v13
  v_dot2_f32_bf16 v14, v234, v37, v14
  v_dot2_f32_bf16 v15, v235, v37, v15
  v_dot2_f32_bf16 v16, v236, v37, v16
  v_dot2_f32_bf16 v17, v237, v37, v17
  v_dot2_f32_bf16 v18, v238, v37, v18
  v_dot2_f32_bf16 v19, v239, v37, v19
  s_waitcnt vmcnt(0)
  v_mov_b32 v40, v20
  v_mov_b32 v41, v40
  s_nop 1
  v_permlane16_swap_b32 v40, v41
  s_nop 0
  v_max_f32 v40, v40, v41
  v_mov_b32 v41, v40
  s_nop 1
  v_permlane32_swap_b32 v40, v41
  s_nop 0
  v_max_f32 v40, v40, v41
  v_sub_f32 v42, v20, v40
  v_mul_f32 v42, s79, v42
  v_exp_f32 v42, v42
  s_nop 0
  v_mul_f32 v21, v21, v42
  v_mul_f32 v12, v12, v42
  v_mul_f32 v13, v13, v42
  v_mul_f32 v14, v14, v42
  v_mul_f32 v15, v15, v42
  v_mul_f32 v16, v16, v42
  v_mul_f32 v17, v17, v42
  v_mul_f32 v18, v18, v42
  v_mul_f32 v19, v19, v42
  v_mov_b32 v41, v21
  s_nop 1
  v_permlane16_swap_b32 v21, v41
  s_nop 0
  v_add_f32 v21, v21, v41
  v_mov_b32 v41, v21
  s_nop 1
  v_permlane32_swap_b32 v21, v41
  s_nop 0
  v_add_f32 v21, v21, v41
  s_nop 1
  v_permlane32_swap_b32 v12, v16
  v_permlane32_swap_b32 v13, v17
  v_permlane32_swap_b32 v14, v18
  v_permlane32_swap_b32 v15, v19
  s_nop 0
  v_add_f32 v12, v12, v16
  v_add_f32 v13, v13, v17
  v_add_f32 v14, v14, v18
  v_add_f32 v15, v15, v19
  s_nop 1
  v_permlane16_swap_b32 v12, v14
  v_permlane16_swap_b32 v13, v15
  s_nop 0
  v_add_f32 v12, v12, v14
  v_add_f32 v13, v13, v15
  s_lshl_b32 s83, s74, 9
  v_add_u32 v43, s83, v61
  ds_write_b64 v43, v[12:13] offset:5632
  v_mov_b32 v41, v21
  s_lshl_b32 s83, s74, 3
  v_mov_b32 v43, s83
  ds_write_b64 v43, v[40:41] offset:9728
  v_mov_b32 v43, 0
  v_add_u32 v44, s73, v1
  v_and_b32 v44, 7, v44
  v_lshlrev_b32 v44, 6, v44
  s_lshl_b32 s83, s74, 3
  v_add_u32 v44, s83, v44
  s_waitcnt lgkmcnt(0)
  s_barrier
  ds_read_b128 v[24:27], v43 offset:9728
  ds_read_b128 v[28:31], v43 offset:9744
  ds_read_b128 v[32:35], v43 offset:9760
  ds_read_b128 v[36:39], v43 offset:9776
  ds_read_b64 v[128:129], v44 offset:5632
  ds_read_b64 v[130:131], v44 offset:6144
  ds_read_b64 v[132:133], v44 offset:6656
  ds_read_b64 v[134:135], v44 offset:7168
  ds_read_b64 v[136:137], v44 offset:7680
  ds_read_b64 v[138:139], v44 offset:8192
  ds_read_b64 v[140:141], v44 offset:8704
  ds_read_b64 v[142:143], v44 offset:9216
  s_waitcnt lgkmcnt(8)
  v_max3_f32 v40, v24, v26, v28
  v_max3_f32 v40, v40, v30, v32
  v_max3_f32 v40, v40, v34, v36
  v_max_f32 v40, v40, v38
  v_sub_f32 v24, v24, v40
  v_sub_f32 v26, v26, v40
  v_sub_f32 v28, v28, v40
  v_sub_f32 v30, v30, v40
  v_sub_f32 v32, v32, v40
  v_sub_f32 v34, v34, v40
  v_sub_f32 v36, v36, v40
  v_sub_f32 v38, v38, v40
  v_mul_f32 v24, s79, v24
  v_mul_f32 v26, s79, v26
  v_mul_f32 v28, s79, v28
  v_mul_f32 v30, s79, v30
  v_mul_f32 v32, s79, v32
  v_mul_f32 v34, s79, v34
  v_mul_f32 v36, s79, v36
  v_mul_f32 v38, s79, v38
  v_exp_f32 v24, v24
  v_exp_f32 v26, v26
  v_exp_f32 v28, v28
  v_exp_f32 v30, v30
  v_exp_f32 v32, v32
  v_exp_f32 v34, v34
  v_exp_f32 v36, v36
  v_exp_f32 v38, v38
  s_waitcnt lgkmcnt(0)
  v_mul_f32 v45, v24, v128
  v_mul_f32 v46, v24, v129
  v_fmac_f32 v45, v26, v130
  v_fmac_f32 v46, v26, v131
  v_fmac_f32 v45, v28, v132
  v_fmac_f32 v46, v28, v133
  v_fmac_f32 v45, v30, v134
  v_fmac_f32 v46, v30, v135
  v_fmac_f32 v45, v32, v136
  v_fmac_f32 v46, v32, v137
  v_fmac_f32 v45, v34, v138
  v_fmac_f32 v46, v34, v139
  v_fmac_f32 v45, v36, v140
  v_fmac_f32 v46, v36, v141
  v_fmac_f32 v45, v38, v142
  v_fmac_f32 v46, v38, v143
  v_cvt_pk_bf16_f32 v45, v45, v46
  v_mul_f32 v41, v24, v25
  v_readlane_b32 s4, v45, 0
  v_readlane_b32 s5, v45, 1
  v_readlane_b32 s6, v45, 2
  v_readlane_b32 s7, v45, 3
  v_readlane_b32 s8, v45, 4
  v_readlane_b32 s9, v45, 5
  v_readlane_b32 s10, v45, 6
  v_readlane_b32 s11, v45, 7
  v_fmac_f32 v41, v26, v27
  v_fmac_f32 v41, v28, v29
  v_fmac_f32 v41, v30, v31
  v_fmac_f32 v41, v32, v33
  v_fmac_f32 v41, v34, v35
  v_fmac_f32 v41, v36, v37
  v_fmac_f32 v41, v38, v39
  v_dot2_f32_bf16 v12, v64, s4, 0
  v_dot2_f32_bf16 v13, v68, s4, 0
  v_dot2_f32_bf16 v14, v65, s4, 0
  v_dot2_f32_bf16 v15, v69, s4, 0
  v_dot2_f32_bf16 v16, v66, s4, 0
  v_dot2_f32_bf16 v17, v70, s4, 0
  v_dot2_f32_bf16 v18, v67, s4, 0
  v_dot2_f32_bf16 v19, v71, s4, 0
  v_dot2_f32_bf16 v12, v72, s5, v12
  v_dot2_f32_bf16 v13, v76, s5, v13
  v_dot2_f32_bf16 v14, v73, s5, v14
  v_dot2_f32_bf16 v15, v77, s5, v15
  v_dot2_f32_bf16 v16, v74, s5, v16
  v_dot2_f32_bf16 v17, v78, s5, v17
  v_dot2_f32_bf16 v18, v75, s5, v18
  v_dot2_f32_bf16 v19, v79, s5, v19
  v_dot2_f32_bf16 v12, v80, s6, v12
  v_dot2_f32_bf16 v13, v84, s6, v13
  v_dot2_f32_bf16 v14, v81, s6, v14
  v_dot2_f32_bf16 v15, v85, s6, v15
  v_dot2_f32_bf16 v16, v82, s6, v16
  v_dot2_f32_bf16 v17, v86, s6, v17
  v_dot2_f32_bf16 v18, v83, s6, v18
  v_dot2_f32_bf16 v19, v87, s6, v19
  v_dot2_f32_bf16 v12, v88, s7, v12
  v_dot2_f32_bf16 v13, v92, s7, v13
  v_dot2_f32_bf16 v14, v89, s7, v14
  v_dot2_f32_bf16 v15, v93, s7, v15
  v_dot2_f32_bf16 v16, v90, s7, v16
  v_dot2_f32_bf16 v17, v94, s7, v17
  v_dot2_f32_bf16 v18, v91, s7, v18
  v_dot2_f32_bf16 v19, v95, s7, v19
  v_dot2_f32_bf16 v12, v96, s8, v12
  v_dot2_f32_bf16 v13, v100, s8, v13
  v_dot2_f32_bf16 v14, v97, s8, v14
  v_dot2_f32_bf16 v15, v101, s8, v15
  v_dot2_f32_bf16 v16, v98, s8, v16
  v_dot2_f32_bf16 v17, v102, s8, v17
  v_dot2_f32_bf16 v18, v99, s8, v18
  v_dot2_f32_bf16 v19, v103, s8, v19
  v_dot2_f32_bf16 v12, v104, s9, v12
  v_dot2_f32_bf16 v13, v108, s9, v13
  v_dot2_f32_bf16 v14, v105, s9, v14
  v_dot2_f32_bf16 v15, v109, s9, v15
  v_dot2_f32_bf16 v16, v106, s9, v16
  v_dot2_f32_bf16 v17, v110, s9, v17
  v_dot2_f32_bf16 v18, v107, s9, v18
  v_dot2_f32_bf16 v19, v111, s9, v19
  v_dot2_f32_bf16 v12, v112, s10, v12
  v_dot2_f32_bf16 v13, v116, s10, v13
  v_dot2_f32_bf16 v14, v113, s10, v14
  v_dot2_f32_bf16 v15, v117, s10, v15
  v_dot2_f32_bf16 v16, v114, s10, v16
  v_dot2_f32_bf16 v17, v118, s10, v17
  v_dot2_f32_bf16 v18, v115, s10, v18
  v_dot2_f32_bf16 v19, v119, s10, v19
  v_dot2_f32_bf16 v12, v120, s11, v12
  v_dot2_f32_bf16 v13, v124, s11, v13
  v_dot2_f32_bf16 v14, v121, s11, v14
  v_dot2_f32_bf16 v15, v125, s11, v15
  v_dot2_f32_bf16 v16, v122, s11, v16
  v_dot2_f32_bf16 v17, v126, s11, v17
  v_dot2_f32_bf16 v18, v123, s11, v18
  v_dot2_f32_bf16 v19, v127, s11, v19
  v_lshlrev_b32 v43, 5, v1
  s_lshl_b32 s83, s74, 11
  v_add_u32 v44, s83, v43
  s_nop 0
  ds_write_b128 v44, v[12:15] offset:10240
  ds_write_b128 v44, v[16:19] offset:10256
  s_waitcnt lgkmcnt(0)
  s_barrier
  v_lshlrev_b32 v43, 11, v3
  v_lshl_add_u32 v43, v4, 4, v43
  s_lshl_b32 s83, s74, 8
  v_add_u32 v43, s83, v43
  ds_read_b128 v[128:131], v43 offset:10240
  ds_read_b128 v[132:135], v43 offset:18432
  v_lshrrev_b32 v44, 3, v4
  v_lshlrev_b32 v44, 15, v44
  v_and_b32 v45, 7, v4
  v_lshl_add_u32 v44, v45, 4, v44
  v_lshl_add_u32 v44, v3, 2, v44
  s_lshl_b32 s83, s74, 16
  s_lshl_b32 s84, s81, 7
  s_add_u32 s83, s83, s84
  s_lshl_b32 s84, s81, 3
  s_add_u32 s84, s84, 1048576
  v_mov_b32 v45, 0
  s_waitcnt lgkmcnt(0)
  v_add_f32 v128, v128, v132
  v_add_f32 v129, v129, v133
  v_add_f32 v130, v130, v134
  v_add_f32 v131, v131, v135
  s_nop 1
  v_permlane32_swap_b32 v128, v130
  v_permlane32_swap_b32 v129, v131
  s_nop 0
  v_add_f32 v128, v128, v130
  v_add_f32 v129, v129, v131
  s_nop 1
  v_permlane16_swap_b32 v128, v129
  s_nop 0
  v_add_f32 v128, v128, v129
  buffer_store_dword v128, v44, s[60:63], s83 offen sc0 sc1
  s_cmp_lg_u32 s74, 0
  s_cbranch_scc1 L_after_pub
  s_mov_b64 exec, 1
  buffer_store_dwordx2 v[40:41], v45, s[60:63], s84 offen sc0 sc1
  s_mov_b64 exec, -1
L_after_pub:
  s_cmp_ge_u32 s2, 32
  s_cbranch_scc1 L_end
  v_lshlrev_b32 v62, 2, v1
  v_and_b32 v62, 0x7f, v62
  s_mov_b32 s76, 0x40000
L_cpoll:
  v_cmp_gt_u32 vcc, 8, v63
  s_cbranch_vccz L_cdone
  s_sub_u32 s76, s76, 1
  s_cmp_eq_u32 s76, 0
  s_cbranch_scc1 L_cdone
  buffer_load_dword v63, v62, s[68:71], 0 offen sc0 sc1
  s_waitcnt vmcnt(0)
  s_branch L_cpoll
L_cdone:
  v_lshrrev_b32 v40, 2, v0
  v_lshlrev_b32 v40, 7, v40
  v_and_b32 v41, 3, v0
  v_lshl_add_u32 v40, v41, 4, v40
  s_lshr_b32 s83, s2, 1
  s_lshl_b32 s83, s83, 15
  s_and_b32 s84, s2, 1
  s_lshl_b32 s84, s84, 6
  s_add_u32 s83, s83, s84
  s_add_u32 s84, s83, 16384
  s_add_u32 s85, s83, 524288
  s_add_u32 s75, s84, 524288
  s_mov_b32 s82, 1048576
  v_and_b32 v41, 15, v1
  v_bfe_u32 v42, v1, 4, 1
  v_lshl_add_u32 v41, v42, 7, v41
  s_lshl_b32 s91, s74, 4
  v_add_u32 v41, s91, v41
  v_lshlrev_b32 v41, 3, v41
  v_and_b32 v45, 15, v0
  v_lshlrev_b32 v45, 1, v45
  s_lshl_b32 s91, s2, 5
  buffer_load_ushort v46, v45, s[56:59], s91 offen
  v_cmp_gt_u32 vcc, 384, v0
  s_mov_b64 s[92:93], vcc
  v_mov_b32 v140, 0
  v_mov_b32 v141, 0
  v_mov_b32 v142, 0
  v_mov_b32 v143, 0
  s_mov_b32 s76, 0x40000
L_mpoll:
  buffer_load_dwordx2 v[144:145], v41, s[60:63], s82 offen sc0 sc1
  s_waitcnt vmcnt(0)
  v_max_u32 v48, v144, v145
  v_cmp_eq_u32 vcc, -1, v48
  s_bcnt1_i32_b64 s91, vcc
  s_cmp_lt_u32 s91, 6
  s_cbranch_scc1 L_mdone
  s_sub_u32 s76, s76, 1
  s_cmp_lg_u32 s76, 0
  s_cbranch_scc1 L_mpoll
L_mdone:
  s_mov_b32 s76, 0x40000
L_dpoll:
  buffer_load_dwordx2 v[144:145], v41, s[60:63], s82 offen sc0 sc1
  buffer_load_dwordx4 v[128:131], v40, s[60:63], s83 offen sc0 sc1
  buffer_load_dwordx4 v[132:135], v40, s[60:63], s84 offen sc0 sc1
  buffer_load_dwordx4 v[136:139], v40, s[60:63], s85 offen sc0 sc1
  s_and_b64 s[94:95], s[92:93], exec
  s_cbranch_scc0 L_nog2
  s_mov_b64 exec, s[92:93]
  buffer_load_dwordx4 v[140:143], v40, s[60:63], s75 offen sc0 sc1
  s_mov_b64 exec, -1
L_nog2:
  s_waitcnt vmcnt(0)
  v_max3_u32 v48, v128, v129, v130
  v_max3_u32 v49, v131, v132, v133
  v_max3_u32 v48, v48, v134, v135
  v_max3_u32 v49, v49, v136, v137
  v_max3_u32 v48, v48, v138, v139
  v_max3_u32 v49, v49, v140, v141
  v_max3_u32 v48, v48, v142, v143
  v_max3_u32 v49, v49, v144, v145
  v_max_u32 v48, v48, v49
  v_cmp_eq_u32 vcc, -1, v48
  s_cbranch_vccz L_ddone
  s_sub_u32 s76, s76, 1
  s_cmp_lg_u32 s76, 0
  s_cbranch_scc1 L_dpoll
L_ddone:
  v_mov_b32 v48, v144
  s_nop 0
  v_max_f32_dpp v48, v48, v48 quad_perm:[1,0,3,2] row_mask:0xf bank_mask:0xf
  s_nop 1
  v_max_f32_dpp v48, v48, v48 quad_perm:[2,3,0,1] row_mask:0xf bank_mask:0xf
  s_nop 1
  v_max_f32_dpp v48, v48, v48 row_half_mirror row_mask:0xf bank_mask:0xf
  s_nop 1
  v_sub_f32 v49, v144, v48
  v_mul_f32 v49, s79, v49
  v_exp_f32 v49, v49
  s_nop 0
  v_mul_f32 v50, v49, v145
  s_nop 1
  v_add_f32_dpp v50, v50, v50 quad_perm:[1,0,3,2] row_mask:0xf bank_mask:0xf
  s_nop 1
  v_add_f32_dpp v50, v50, v50 quad_perm:[2,3,0,1] row_mask:0xf bank_mask:0xf
  s_nop 1
  v_add_f32_dpp v50, v50, v50 row_half_mirror row_mask:0xf bank_mask:0xf
  s_nop 1
  v_rcp_f32 v51, v50
  s_nop 0
  v_fma_f32 v48, -v50, v51, 1.0
  v_fma_f32 v51, v48, v51, v51
  v_mul_f32 v51, v51, v49
  v_and_b32 v41, 0x3c, v1
  v_add_u32 v42, 64, v41
  ds_bpermute_b32 v48, v41, v51
  ds_bpermute_b32 v49, v42, v51
  v_add_f32 v136, v136, v140
  v_add_f32 v137, v137, v141
  v_add_f32 v138, v138, v142
  v_add_f32 v139, v139, v143
  s_waitcnt lgkmcnt(0)
  v_mul_f32 v128, v48, v128
  v_mul_f32 v129, v48, v129
  v_mul_f32 v130, v48, v130
  v_mul_f32 v131, v48, v131
  v_fmac_f32 v128, v49, v132
  v_fmac_f32 v129, v49, v133
  v_fmac_f32 v130, v49, v134
  v_fmac_f32 v131, v49, v135
  s_nop 1
  v_add_f32_dpp v128, v128, v128 row_ror:4 row_mask:0xf bank_mask:0xf
  v_add_f32_dpp v129, v129, v129 row_ror:4 row_mask:0xf bank_mask:0xf
  v_add_f32_dpp v130, v130, v130 row_ror:4 row_mask:0xf bank_mask:0xf
  v_add_f32_dpp v131, v131, v131 row_ror:4 row_mask:0xf bank_mask:0xf
  v_add_f32_dpp v136, v136, v136 row_ror:4 row_mask:0xf bank_mask:0xf
  v_add_f32_dpp v137, v137, v137 row_ror:4 row_mask:0xf bank_mask:0xf
  v_add_f32_dpp v138, v138, v138 row_ror:4 row_mask:0xf bank_mask:0xf
  v_add_f32_dpp v139, v139, v139 row_ror:4 row_mask:0xf bank_mask:0xf
  v_add_f32_dpp v128, v128, v128 row_ror:8 row_mask:0xf bank_mask:0xf
  v_add_f32_dpp v129, v129, v129 row_ror:8 row_mask:0xf bank_mask:0xf
  v_add_f32_dpp v130, v130, v130 row_ror:8 row_mask:0xf bank_mask:0xf
  v_add_f32_dpp v131, v131, v131 row_ror:8 row_mask:0xf bank_mask:0xf
  v_add_f32_dpp v136, v136, v136 row_ror:8 row_mask:0xf bank_mask:0xf
  v_add_f32_dpp v137, v137, v137 row_ror:8 row_mask:0xf bank_mask:0xf
  v_add_f32_dpp v138, v138, v138 row_ror:8 row_mask:0xf bank_mask:0xf
  v_add_f32_dpp v139, v139, v139 row_ror:8 row_mask:0xf bank_mask:0xf
  s_nop 1
  v_permlane32_swap_b32 v128, v136
  v_permlane32_swap_b32 v129, v137
  v_permlane32_swap_b32 v130, v138
  v_permlane32_swap_b32 v131, v139
  s_nop 0
  v_add_f32 v128, v128, v136
  v_add_f32 v129, v129, v137
  v_add_f32 v130, v130, v138
  v_add_f32 v131, v131, v139
  s_nop 1
  v_permlane16_swap_b32 v128, v130
  v_permlane16_swap_b32 v129, v131
  s_nop 0
  v_add_f32 v128, v128, v130
  v_add_f32 v129, v129, v131
  v_and_b32 v40, 3, v1
  v_lshlrev_b32 v40, 4, v40
  v_and_b32 v41, 1, v3
  v_lshl_add_u32 v40, v41, 3, v40
  v_lshrrev_b32 v41, 1, v3
  v_lshl_add_u32 v40, v41, 6, v40
  s_lshl_b32 s83, s74, 7
  v_add_u32 v40, s83, v40
  ds_write_b64 v40, v[128:129] offset:26624
  s_waitcnt lgkmcnt(0)
  s_barrier
  s_cmp_lg_u32 s74, 0
  s_cbranch_scc1 L_end2
  v_and_b32 v40, 15, v1
  v_lshlrev_b32 v40, 2, v40
  ds_read_b32 v144, v40 offset:26624
  ds_read_b32 v152, v40 offset:26688
  ds_read_b32 v145, v40 offset:26752
  ds_read_b32 v153, v40 offset:26816
  ds_read_b32 v146, v40 offset:26880
  ds_read_b32 v154, v40 offset:26944
  ds_read_b32 v147, v40 offset:27008
  ds_read_b32 v155, v40 offset:27072
  ds_read_b32 v148, v40 offset:27136
  ds_read_b32 v156, v40 offset:27200
  ds_read_b32 v149, v40 offset:27264
  ds_read_b32 v157, v40 offset:27328
  ds_read_b32 v150, v40 offset:27392
  ds_read_b32 v158, v40 offset:27456
  ds_read_b32 v151, v40 offset:27520
  ds_read_b32 v159, v40 offset:27584
  s_waitcnt lgkmcnt(0)
  v_add_f32 v144, v144, v145
  v_add_f32 v152, v152, v153
  v_add_f32 v146, v146, v147
  v_add_f32 v154, v154, v155
  v_add_f32 v148, v148, v149
  v_add_f32 v156, v156, v157
  v_add_f32 v150, v150, v151
  v_add_f32 v158, v158, v159
  v_add_f32 v144, v144, v146
  v_add_f32 v152, v152, v154
  v_add_f32 v148, v148, v150
  v_add_f32 v156, v156, v158
  v_add_f32 v144, v144, v148
  v_add_f32 v152, v152, v156
  v_cvt_pk_bf16_f32 v41, v144, v152
  v_lshlrev_b32 v144, 16, v41
  v_and_b32 v152, s80, v41
  v_lshlrev_b32 v46, 16, v46
  v_add_f32 v46, v46, v144
  v_cvt_pk_bf16_f32 v41, v46, v46
  v_lshlrev_b32 v46, 16, v41
  v_add_f32 v46, v46, v152
  v_cvt_pk_bf16_f32 v46, v46, v46
  v_cmp_gt_u32 vcc, 16, v1
  s_and_saveexec_b64 s[96:97], vcc
  s_lshl_b32 s85, s2, 5
  buffer_store_short v46, v45, s[64:67], s85 offen
L_end2:
L_end:
  s_endpgm
.section .rodata,"a"
.p2align 6
.amdhsa_kernel parallel_sum__mha_block_cached__glu_gated_glu__decode_kernel
  .amdhsa_next_free_vgpr 256
  .amdhsa_next_free_sgpr 102
  .amdhsa_accum_offset 256
  .amdhsa_group_segment_fixed_size 0
  .amdhsa_kernarg_size 96
  .amdhsa_user_sgpr_count 2
  .amdhsa_user_sgpr_kernarg_segment_ptr 1
  .amdhsa_system_sgpr_workgroup_id_x 1
.end_amdhsa_kernel
```
